```python
import torch

def _softmax(x, axis=-1):
    return torch.softmax(x, dim=axis)
def _gelu(x):
    return torch.nn.functional.gelu(x, approximate="tanh")
def _silu(x):
    return torch.nn.functional.silu(x)
def _sigmoid(x):
    return torch.sigmoid(x)
def _layernorm(x, axis=-1, eps=1e-5):
    m = x.mean(dim=axis, keepdim=True)
    v = x.var(dim=axis, keepdim=True, unbiased=False)
    return (x - m) / torch.sqrt(v + eps)
def _scatter_add(tgt, idx, src, axis=0):
    return tgt.clone().index_add_(axis, idx, src)
def _segment_sum(src, seg, n):
    out = torch.zeros((n,) + src.shape[1:], dtype=src.dtype)
    return out.index_add_(0, seg, src)
def _pad(x, pw):
    flat = tuple(v for pair in reversed(pw) for v in pair)
    return torch.nn.functional.pad(x, flat)

kernel_name = 'recurrent_scan__gqa_block_cached__mixer_channel_mlp__decode'

def setup_inputs():

    _w = (lambda a: (lambda t: t.to(torch.bfloat16) if t.is_floating_point() else t)(torch.as_tensor(a)))
    def _A_setup():
        B, Sq, D = 4, 1, 512
        Hq, Hkv, Sk, Dh = 32, 8, 16384, 128
        assert Hq % Hkv == 0, (Hq, Hkv)
        return {
            "x": _w((lambda *s: torch.randn(*s, dtype=torch.bfloat16) * 0.1)(B, Sq, D)),
            "k_cache": _w((lambda *s: torch.randn(*s, dtype=torch.bfloat16) * 0.8)(B, Hkv, Sk, Dh)),
            "v_cache": _w((lambda *s: torch.randn(*s, dtype=torch.bfloat16) * 3.2)(B, Hkv, Sk, Dh)),
            "wq": _w((lambda *s: torch.randn(*s, dtype=torch.bfloat16) * 0.8)(D, Hq * Dh) * (D ** -0.5)),
            "wo": _w((lambda *s: torch.randn(*s, dtype=torch.bfloat16) * 3.2)(Hq * Dh, D) * ((Hq * Dh) ** -0.5)),
        }
    _A_in = _A_setup()

    def _B_setup():
        B, S, D, F = 4, 1, 512, 1792
        return {
            "x": _w((lambda *s: torch.randn(*s, dtype=torch.bfloat16) * 0.1)(B, S, D)),
            "w1": _w((lambda *s: torch.randn(*s, dtype=torch.bfloat16) * 3.2)(D, F) * (D ** -0.5)),
            "b1": _w((lambda *s: torch.randn(*s, dtype=torch.bfloat16) * 3.2)(F)),
            "w2": _w((lambda *s: torch.randn(*s, dtype=torch.bfloat16) * 3.2)(F, D) * (F ** -0.5)),
            "b2": _w((lambda *s: torch.randn(*s, dtype=torch.bfloat16) * 3.2)(D)),
        }
    _B_in = _B_setup()

    return {
        "A_x": _A_in["x"],
        "A_k_cache": _A_in["k_cache"],
        "A_v_cache": _A_in["v_cache"],
        "A_wq": _A_in["wq"],
        "A_wo": _A_in["wo"],
        "B_x": _B_in["x"],
        "B_w1": _B_in["w1"],
        "B_b1": _B_in["b1"],
        "B_w2": _B_in["w2"],
        "B_b2": _B_in["b2"],
    }

def reference(A_x, A_k_cache, A_v_cache, A_wq, A_wo, B_x, B_w1, B_b1, B_w2, B_b2):
    def _A_ref(x, k_cache, v_cache, wq, wo):
        B, Sq, D = x.shape
        Hq, Dh = 32, 128
        Hkv = k_cache.shape[1]
        rep = Hq // Hkv
        q = (lambda x, *d: x.permute(*d))((x @ wq).reshape(B, Sq, Hq, Dh), 0, 2, 1, 3)
        k = (lambda x, n, axis: torch.repeat_interleave(x, n, dim=axis))(k_cache, rep, axis=1)
        v = (lambda x, n, axis: torch.repeat_interleave(x, n, dim=axis))(v_cache, rep, axis=1)
        scores = torch.einsum("bhqd,bhkd->bhqk", q, k) * (Dh ** -0.5)
        p = _softmax(scores, axis=-1)
        o = torch.einsum("bhqk,bhkd->bhqd", p, v)
        return (lambda x, *d: x.permute(*d))(o, 0, 2, 1, 3).reshape(B, Sq, Hq * Dh) @ wo

    def _B_ref(x, w1, b1, w2, b2):
        y = _layernorm(x, axis=-1)
        h = _gelu(torch.einsum("bsd,df->bsf", y, w1) + b1)
        return torch.einsum("bsf,fd->bsd", h, w2) + b2

    x = A_x
    xn = _layernorm(x, axis=-1)
    s = _A_ref(xn, A_k_cache, A_v_cache, A_wq, A_wo)
    g = _silu(_B_ref(xn, B_w1, B_b1, B_w2, B_b2))
    return x + s * g
```

```asm
; @launch grid=(256,1,1) block=(512,1,1) lds=40960
.amdgcn_target "amdgcn-amd-amdhsa--gfx950"
.text
.globl recurrent_scan__gqa_block_cached__mixer_channel_mlp__decode_kernel
.p2align 8
.type recurrent_scan__gqa_block_cached__mixer_channel_mlp__decode_kernel,@function
recurrent_scan__gqa_block_cached__mixer_channel_mlp__decode_kernel:
    s_cmp_ge_u32 s2, 256
    s_cbranch_scc1 K2_end
    s_mov_b32 s58, s2
    s_lshr_b32 s3, s2, 4
    s_add_u32 s57, s2, s3
    s_and_b32 s57, s57, 7
    s_mul_i32 s3, s3, 6
    s_add_u32 s3, s3, s57
    s_lshl_b32 s3, s3, 1
    s_bfe_u32 s56, s2, 0x10003
    s_add_u32 s3, s3, s56
    s_cmp_ge_u32 s57, 6
    s_cselect_b32 s3, 255, s3
    s_lshr_b32 s56, s2, 3
    s_add_u32 s57, s2, s56
    s_and_b32 s57, s57, 7
    s_mul_i32 s56, s56, 3
    s_add_u32 s56, s56, s57
    s_sub_u32 s56, s56, 5
    s_cmp_ge_u32 s57, 5
    s_cselect_b32 s57, s56, 255
    s_load_dwordx2 s[4:5], s[0:1], 8
    s_load_dwordx2 s[6:7], s[0:1], 16
    s_load_dwordx2 s[8:9], s[0:1], 96
    s_load_dwordx2 s[10:11], s[0:1], 0
    s_load_dwordx2 s[48:49], s[0:1], 24
    s_load_dwordx2 s[50:51], s[0:1], 48
    s_load_dwordx2 s[52:53], s[0:1], 88
    s_load_dwordx2 s[54:55], s[0:1], 56
    v_and_b32 v3, 63, v0
    v_lshrrev_b32 v1, 6, v0
    s_nop 0
    v_readfirstlane_b32 s30, v1
    s_mov_b32 s40, 0x05040100
    s_mov_b32 s41, 0x07060302
    v_lshrrev_b32 v1, 4, v3
    v_cmp_eq_u32 s[42:43], 1, v1
    v_cmp_eq_u32 s[44:45], 2, v1
    v_cmp_eq_u32 s[46:47], 3, v1
    v_mov_b32 v1, v3
    s_mov_b32 s26, 0x05040100
    s_mov_b32 s27, 0x07060302
    s_mov_b32 s28, 0x3fb8aa3b
    s_mov_b32 s38, 0x3db504f3
    v_and_b32 v2, 3, v1
    v_cmp_eq_u32 s[32:33], 1, v2
    v_cmp_eq_u32 s[34:35], 2, v2
    v_cmp_eq_u32 s[36:37], 3, v2
    v_bfe_u32 v224, v1, 2, 2
    v_lshlrev_b32 v224, 8, v224
    v_lshrrev_b32 v22, 4, v1
    v_lshl_add_u32 v22, v22, 2, v2
    v_lshl_add_u32 v224, v22, 4, v224
    v_lshlrev_b32 v225, 4, v1
    s_waitcnt lgkmcnt(0)
    s_lshr_b32 s24, s2, 3
    s_lshl_b32 s24, s24, 22
    s_add_u32 s4, s4, s24
    s_addc_u32 s5, s5, 0
    s_add_u32 s6, s6, s24
    s_addc_u32 s7, s7, 0
    s_mov_b32 s12, s4
    s_and_b32 s13, s5, 0xffff
    s_mov_b32 s14, 0x400000
    s_mov_b32 s15, 0x00020000
    s_mov_b32 s16, s6
    s_and_b32 s17, s7, 0xffff
    s_mov_b32 s18, 0x400000
    s_mov_b32 s19, 0x00020000
    s_and_b32 s31, s2, 7
    s_mul_i32 s31, s31, 48
    s_add_u32 s31, s31, s30
    s_lshl_b32 s29, s31, 13
    s_mov_b32 s20, s8
    s_and_b32 s21, s9, 0xffff
    s_mov_b32 s22, 0x1000000
    s_mov_b32 s23, 0x00020000
    s_mov_b32 s72, s52
    s_and_b32 s73, s53, 0xffff
    s_mov_b32 s74, 0x100
    s_mov_b32 s75, 0x00020000
    s_cmp_eq_u32 s30, 0
    s_cbranch_scc1 K2_proj
    s_cmp_lg_u32 s2, 0
    s_cbranch_scc1 K2_nononce
    s_cmp_lg_u32 s30, 1
    s_cbranch_scc1 K2_nononce
    s_memrealtime s[62:63]
    s_waitcnt lgkmcnt(0)
    s_or_b32 s62, s62, 1
    v_mov_b32 v6, s62
    v_mov_b32 v7, 128
    s_mov_b64 exec, 1
    buffer_store_dword v6, v7, s[72:75], 0 offen sc0 sc1
    s_mov_b64 exec, -1
    v_mul_u32_u24 v5, 4352, v3
    v_mov_b32 v4, 0
    s_mov_b32 s63, 5242880
    buffer_store_dword v4, v5, s[20:23], s63 offen sc0 sc1
    s_waitcnt vmcnt(0)
    s_mov_b64 exec, 1
    buffer_store_dword v6, v7, s[72:75], 0 offen offset:4 sc0 sc1
    s_mov_b64 exec, -1
K2_nononce:
    s_cmp_lg_u32 s30, 1
    s_cbranch_scc1 K2_noflag
    v_mov_b32 v8, 0
    v_mov_b32 v9, 19456
    ds_write_b32 v9, v8
    ds_write_b32 v9, v8 offset:4
    s_waitcnt lgkmcnt(0)
K2_noflag:
    s_barrier
    s_mov_b32 s24, s29
    s_add_u32 s25, s29, 4096
    s_waitcnt vmcnt(5)
    buffer_load_dwordx4 v[96:99], v224, s[12:15], s24 offen nt
    s_waitcnt vmcnt(5)
    buffer_load_dwordx4 v[100:103], v224, s[12:15], s24 offen offset:1024 nt
    s_waitcnt vmcnt(5)
    buffer_load_dwordx4 v[104:107], v224, s[12:15], s24 offen offset:2048 nt
    s_waitcnt vmcnt(5)
    buffer_load_dwordx4 v[108:111], v224, s[12:15], s24 offen offset:3072 nt
    s_waitcnt vmcnt(5)
    buffer_load_dwordx4 v[112:115], v224, s[12:15], s25 offen nt
    s_waitcnt vmcnt(5)
    buffer_load_dwordx4 v[116:119], v224, s[12:15], s25 offen offset:1024 nt
    s_waitcnt vmcnt(5)
    buffer_load_dwordx4 v[120:123], v224, s[12:15], s25 offen offset:2048 nt
    s_waitcnt vmcnt(5)
    buffer_load_dwordx4 v[124:127], v224, s[12:15], s25 offen offset:3072 nt
    s_waitcnt vmcnt(5)
    buffer_load_dwordx4 v[128:131], v225, s[16:19], s24 offen nt
    s_waitcnt vmcnt(5)
    buffer_load_dwordx4 v[132:135], v225, s[16:19], s24 offen offset:1024 nt
    s_waitcnt vmcnt(5)
    buffer_load_dwordx4 v[136:139], v225, s[16:19], s24 offen offset:2048 nt
    s_waitcnt vmcnt(5)
    buffer_load_dwordx4 v[140:143], v225, s[16:19], s24 offen offset:3072 nt
    s_waitcnt vmcnt(5)
    buffer_load_dwordx4 v[144:147], v225, s[16:19], s25 offen nt
    s_waitcnt vmcnt(5)
    buffer_load_dwordx4 v[148:151], v225, s[16:19], s25 offen offset:1024 nt
    s_waitcnt vmcnt(5)
    buffer_load_dwordx4 v[152:155], v225, s[16:19], s25 offen offset:2048 nt
    s_waitcnt vmcnt(5)
    buffer_load_dwordx4 v[156:159], v225, s[16:19], s25 offen offset:3072 nt
    s_add_u32 s24, s29, 65536
    s_add_u32 s25, s29, 69632
    s_waitcnt vmcnt(5)
    buffer_load_dwordx4 v[160:163], v224, s[12:15], s24 offen nt
    s_waitcnt vmcnt(5)
    buffer_load_dwordx4 v[164:167], v224, s[12:15], s24 offen offset:1024 nt
    s_waitcnt vmcnt(5)
    buffer_load_dwordx4 v[168:171], v224, s[12:15], s24 offen offset:2048 nt
    s_waitcnt vmcnt(5)
    buffer_load_dwordx4 v[172:175], v224, s[12:15], s24 offen offset:3072 nt
    s_waitcnt vmcnt(5)
    buffer_load_dwordx4 v[176:179], v224, s[12:15], s25 offen nt
    s_waitcnt vmcnt(5)
    buffer_load_dwordx4 v[180:183], v224, s[12:15], s25 offen offset:1024 nt
    s_waitcnt vmcnt(5)
    buffer_load_dwordx4 v[184:187], v224, s[12:15], s25 offen offset:2048 nt
    s_waitcnt vmcnt(5)
    buffer_load_dwordx4 v[188:191], v224, s[12:15], s25 offen offset:3072 nt
    s_waitcnt vmcnt(5)
    buffer_load_dwordx4 v[192:195], v225, s[16:19], s24 offen nt
    s_waitcnt vmcnt(5)
    buffer_load_dwordx4 v[196:199], v225, s[16:19], s24 offen offset:1024 nt
    s_waitcnt vmcnt(5)
    buffer_load_dwordx4 v[200:203], v225, s[16:19], s24 offen offset:2048 nt
    s_waitcnt vmcnt(5)
    buffer_load_dwordx4 v[204:207], v225, s[16:19], s24 offen offset:3072 nt
    s_waitcnt vmcnt(5)
    buffer_load_dwordx4 v[208:211], v225, s[16:19], s25 offen nt
    s_waitcnt vmcnt(5)
    buffer_load_dwordx4 v[212:215], v225, s[16:19], s25 offen offset:1024 nt
    s_waitcnt vmcnt(5)
    buffer_load_dwordx4 v[216:219], v225, s[16:19], s25 offen offset:2048 nt
    s_waitcnt vmcnt(5)
    buffer_load_dwordx4 v[220:223], v225, s[16:19], s25 offen offset:3072 nt
    s_branch K2_qwait
K2_proj:
    s_cmp_lt_u32 s3, 184
    s_cbranch_scc1 K2_task
    s_barrier
    s_branch K2_getnonce
K2_task:
    s_mov_b32 s64, s10
    s_and_b32 s65, s11, 0xffff
    s_mov_b32 s66, 0x1000
    s_mov_b32 s67, 0x00020000
    s_cmp_ge_u32 s3, 128
    s_cbranch_scc1 K1_mlp
    s_mov_b32 s68, s48
    s_and_b32 s69, s49, 0xffff
    s_mov_b32 s70, 0x400000
    s_mov_b32 s71, 0x00020000
    s_mov_b32 s76, s3
    s_mov_b32 s78, 8192
    s_mov_b32 s81, 0
    s_branch K1_go
K1_mlp:
    s_mov_b32 s68, s50
    s_and_b32 s69, s51, 0xffff
    s_mov_b32 s70, 0x1c0000
    s_mov_b32 s71, 0x00020000
    s_sub_u32 s76, s3, 128
    s_mov_b32 s78, 3584
    s_mov_b32 s81, 1
K1_go:
    v_lshlrev_b32 v1, 6, v3
    buffer_load_dwordx4 v[64:67], v1, s[64:67], 0 offen offset:0
    buffer_load_dwordx4 v[68:71], v1, s[64:67], 0 offen offset:16
    buffer_load_dwordx4 v[72:75], v1, s[64:67], 0 offen offset:32
    buffer_load_dwordx4 v[76:79], v1, s[64:67], 0 offen offset:48
    v_and_b32 v1, 3, v3
    v_bfe_u32 v22, v3, 2, 2
    v_lshrrev_b32 v2, 4, v3
    v_lshlrev_b32 v23, 10, v1
    v_lshl_add_u32 v23, v22, 8, v23
    v_lshl_add_u32 v23, v2, 4, v23
    buffer_load_dwordx4 v[80:83], v23, s[64:67], 0 offen offset:0
    buffer_load_dwordx4 v[84:87], v23, s[64:67], 0 offen offset:64
    buffer_load_dwordx4 v[88:91], v23, s[64:67], 0 offen offset:128
    buffer_load_dwordx4 v[92:95], v23, s[64:67], 0 offen offset:192
    v_lshlrev_b32 v23, 7, v22
    v_lshl_add_u32 v23, v2, 3, v23
    v_mul_lo_u32 v23, v23, s78
    v_lshl_add_u32 v23, v1, 4, v23
    s_lshl_b32 s84, s76, 6
    v_add_u32 v23, s84, v23
    s_mov_b32 s85, 0
    s_mul_i32 s84, s78, 25
    buffer_load_dwordx4 v[96:99], v23, s[68:71], s85 offen nt
    s_add_u32 s85, s85, s78
    buffer_load_dwordx4 v[100:103], v23, s[68:71], s85 offen nt
    s_add_u32 s85, s85, s78
    buffer_load_dwordx4 v[104:107], v23, s[68:71], s85 offen nt
    s_add_u32 s85, s85, s78
    buffer_load_dwordx4 v[108:111], v23, s[68:71], s85 offen nt
    s_add_u32 s85, s85, s78
    buffer_load_dwordx4 v[112:115], v23, s[68:71], s85 offen nt
    s_add_u32 s85, s85, s78
    buffer_load_dwordx4 v[116:119], v23, s[68:71], s85 offen nt
    s_add_u32 s85, s85, s78
    buffer_load_dwordx4 v[120:123], v23, s[68:71], s85 offen nt
    s_add_u32 s85, s85, s78
    buffer_load_dwordx4 v[124:127], v23, s[68:71], s85 offen nt
    s_add_u32 s85, s85, s84
    buffer_load_dwordx4 v[128:131], v23, s[68:71], s85 offen nt
    s_add_u32 s85, s85, s78
    buffer_load_dwordx4 v[132:135], v23, s[68:71], s85 offen nt
    s_add_u32 s85, s85, s78
    buffer_load_dwordx4 v[136:139], v23, s[68:71], s85 offen nt
    s_add_u32 s85, s85, s78
    buffer_load_dwordx4 v[140:143], v23, s[68:71], s85 offen nt
    s_add_u32 s85, s85, s78
    buffer_load_dwordx4 v[144:147], v23, s[68:71], s85 offen nt
    s_add_u32 s85, s85, s78
    buffer_load_dwordx4 v[148:151], v23, s[68:71], s85 offen nt
    s_add_u32 s85, s85, s78
    buffer_load_dwordx4 v[152:155], v23, s[68:71], s85 offen nt
    s_add_u32 s85, s85, s78
    buffer_load_dwordx4 v[156:159], v23, s[68:71], s85 offen nt
    s_add_u32 s85, s85, s84
    buffer_load_dwordx4 v[160:163], v23, s[68:71], s85 offen nt
    s_add_u32 s85, s85, s78
    buffer_load_dwordx4 v[164:167], v23, s[68:71], s85 offen nt
    s_add_u32 s85, s85, s78
    buffer_load_dwordx4 v[168:171], v23, s[68:71], s85 offen nt
    s_add_u32 s85, s85, s78
    buffer_load_dwordx4 v[172:175], v23, s[68:71], s85 offen nt
    s_add_u32 s85, s85, s78
    buffer_load_dwordx4 v[176:179], v23, s[68:71], s85 offen nt
    s_add_u32 s85, s85, s78
    buffer_load_dwordx4 v[180:183], v23, s[68:71], s85 offen nt
    s_add_u32 s85, s85, s78
    buffer_load_dwordx4 v[184:187], v23, s[68:71], s85 offen nt
    s_add_u32 s85, s85, s78
    buffer_load_dwordx4 v[188:191], v23, s[68:71], s85 offen nt
    s_add_u32 s85, s85, s84
    buffer_load_dwordx4 v[192:195], v23, s[68:71], s85 offen nt
    s_add_u32 s85, s85, s78
    buffer_load_dwordx4 v[196:199], v23, s[68:71], s85 offen nt
    s_add_u32 s85, s85, s78
    buffer_load_dwordx4 v[200:203], v23, s[68:71], s85 offen nt
    s_add_u32 s85, s85, s78
    buffer_load_dwordx4 v[204:207], v23, s[68:71], s85 offen nt
    s_add_u32 s85, s85, s78
    buffer_load_dwordx4 v[208:211], v23, s[68:71], s85 offen nt
    s_add_u32 s85, s85, s78
    buffer_load_dwordx4 v[212:215], v23, s[68:71], s85 offen nt
    s_add_u32 s85, s85, s78
    buffer_load_dwordx4 v[216:219], v23, s[68:71], s85 offen nt
    s_add_u32 s85, s85, s78
    buffer_load_dwordx4 v[220:223], v23, s[68:71], s85 offen nt
    s_barrier
    v_cmp_eq_u32 s[82:83], v2, v22
    v_lshlrev_b32 v227, 9, v22
    v_lshl_add_u32 v227, v1, 5, v227
    v_lshlrev_b32 v2, 6, v1
    s_waitcnt vmcnt(36)
    s_cmp_eq_u32 s81, 0
    s_cbranch_scc1 K1_ldnonce
    s_mov_b32 s64, s54
    s_and_b32 s65, s55, 0xffff
    s_mov_b32 s66, 0xe00
    s_mov_b32 s67, 0x00020000
    v_and_b32 v22, 15, v3
    v_lshlrev_b32 v22, 2, v22
    s_lshl_b32 s84, s76, 6
    buffer_load_dword v226, v22, s[64:67], s84 offen
    s_branch K1_ldnonce_done
K1_ldnonce:
    v_mov_b32 v22, 128
    buffer_load_dword v226, v22, s[72:75], 0 offen sc0 sc1
K1_ldnonce_done:
    v_lshlrev_b32 v32, 16, v64
    v_and_b32 v33, 0xffff0000, v64
    v_lshlrev_b32 v34, 16, v65
    v_and_b32 v35, 0xffff0000, v65
    v_lshlrev_b32 v36, 16, v66
    v_and_b32 v37, 0xffff0000, v66
    v_lshlrev_b32 v38, 16, v67
    v_and_b32 v39, 0xffff0000, v67
    v_lshlrev_b32 v40, 16, v68
    v_and_b32 v41, 0xffff0000, v68
    v_lshlrev_b32 v42, 16, v69
    v_and_b32 v43, 0xffff0000, v69
    v_lshlrev_b32 v44, 16, v70
    v_and_b32 v45, 0xffff0000, v70
    v_lshlrev_b32 v46, 16, v71
    v_and_b32 v47, 0xffff0000, v71
    v_lshlrev_b32 v48, 16, v72
    v_and_b32 v49, 0xffff0000, v72
    v_lshlrev_b32 v50, 16, v73
    v_and_b32 v51, 0xffff0000, v73
    v_lshlrev_b32 v52, 16, v74
    v_and_b32 v53, 0xffff0000, v74
    v_lshlrev_b32 v54, 16, v75
    v_and_b32 v55, 0xffff0000, v75
    v_lshlrev_b32 v56, 16, v76
    v_and_b32 v57, 0xffff0000, v76
    v_lshlrev_b32 v58, 16, v77
    v_and_b32 v59, 0xffff0000, v77
    v_lshlrev_b32 v60, 16, v78
    v_and_b32 v61, 0xffff0000, v78
    v_lshlrev_b32 v62, 16, v79
    v_and_b32 v63, 0xffff0000, v79
    v_add_f32 v22, v32, v33
    v_add_f32 v23, v34, v35
    v_add_f32 v22, v22, v36
    v_add_f32 v23, v23, v37
    v_add_f32 v22, v22, v38
    v_add_f32 v23, v23, v39
    v_add_f32 v22, v22, v40
    v_add_f32 v23, v23, v41
    v_add_f32 v22, v22, v42
    v_add_f32 v23, v23, v43
    v_add_f32 v22, v22, v44
    v_add_f32 v23, v23, v45
    v_add_f32 v22, v22, v46
    v_add_f32 v23, v23, v47
    v_add_f32 v22, v22, v48
    v_add_f32 v23, v23, v49
    v_add_f32 v22, v22, v50
    v_add_f32 v23, v23, v51
    v_add_f32 v22, v22, v52
    v_add_f32 v23, v23, v53
    v_add_f32 v22, v22, v54
    v_add_f32 v23, v23, v55
    v_add_f32 v22, v22, v56
    v_add_f32 v23, v23, v57
    v_add_f32 v22, v22, v58
    v_add_f32 v23, v23, v59
    v_add_f32 v22, v22, v60
    v_add_f32 v23, v23, v61
    v_add_f32 v22, v22, v62
    v_add_f32 v23, v23, v63
    v_add_f32 v22, v22, v23
    s_nop 1
    v_add_f32_dpp v22, v22, v22 quad_perm:[1,0,3,2] row_mask:0xf bank_mask:0xf
    s_nop 1
    v_add_f32_dpp v22, v22, v22 quad_perm:[2,3,0,1] row_mask:0xf bank_mask:0xf
    s_nop 1
    v_add_f32_dpp v22, v22, v22 row_half_mirror row_mask:0xf bank_mask:0xf
    s_nop 1
    v_add_f32_dpp v22, v22, v22 row_mirror row_mask:0xf bank_mask:0xf
    v_mul_f32 v20, 0x3b000000, v22
    v_sub_f32 v23, v32, v20
    v_mul_f32 v22, v23, v23
    v_sub_f32 v23, v33, v20
    v_fmac_f32 v22, v23, v23
    v_sub_f32 v23, v34, v20
    v_fmac_f32 v22, v23, v23
    v_sub_f32 v23, v35, v20
    v_fmac_f32 v22, v23, v23
    v_sub_f32 v23, v36, v20
    v_fmac_f32 v22, v23, v23
    v_sub_f32 v23, v37, v20
    v_fmac_f32 v22, v23, v23
    v_sub_f32 v23, v38, v20
    v_fmac_f32 v22, v23, v23
    v_sub_f32 v23, v39, v20
    v_fmac_f32 v22, v23, v23
    v_sub_f32 v23, v40, v20
    v_fmac_f32 v22, v23, v23
    v_sub_f32 v23, v41, v20
    v_fmac_f32 v22, v23, v23
    v_sub_f32 v23, v42, v20
    v_fmac_f32 v22, v23, v23
    v_sub_f32 v23, v43, v20
    v_fmac_f32 v22, v23, v23
    v_sub_f32 v23, v44, v20
    v_fmac_f32 v22, v23, v23
    v_sub_f32 v23, v45, v20
    v_fmac_f32 v22, v23, v23
    v_sub_f32 v23, v46, v20
    v_fmac_f32 v22, v23, v23
    v_sub_f32 v23, v47, v20
    v_fmac_f32 v22, v23, v23
    v_sub_f32 v23, v48, v20
    v_fmac_f32 v22, v23, v23
    v_sub_f32 v23, v49, v20
    v_fmac_f32 v22, v23, v23
    v_sub_f32 v23, v50, v20
    v_fmac_f32 v22, v23, v23
    v_sub_f32 v23, v51, v20
    v_fmac_f32 v22, v23, v23
    v_sub_f32 v23, v52, v20
    v_fmac_f32 v22, v23, v23
    v_sub_f32 v23, v53, v20
    v_fmac_f32 v22, v23, v23
    v_sub_f32 v23, v54, v20
    v_fmac_f32 v22, v23, v23
    v_sub_f32 v23, v55, v20
    v_fmac_f32 v22, v23, v23
    v_sub_f32 v23, v56, v20
    v_fmac_f32 v22, v23, v23
    v_sub_f32 v23, v57, v20
    v_fmac_f32 v22, v23, v23
    v_sub_f32 v23, v58, v20
    v_fmac_f32 v22, v23, v23
    v_sub_f32 v23, v59, v20
    v_fmac_f32 v22, v23, v23
    v_sub_f32 v23, v60, v20
    v_fmac_f32 v22, v23, v23
    v_sub_f32 v23, v61, v20
    v_fmac_f32 v22, v23, v23
    v_sub_f32 v23, v62, v20
    v_fmac_f32 v22, v23, v23
    v_sub_f32 v23, v63, v20
    v_fmac_f32 v22, v23, v23
    s_nop 1
    v_add_f32_dpp v22, v22, v22 quad_perm:[1,0,3,2] row_mask:0xf bank_mask:0xf
    s_nop 1
    v_add_f32_dpp v22, v22, v22 quad_perm:[2,3,0,1] row_mask:0xf bank_mask:0xf
    s_nop 1
    v_add_f32_dpp v22, v22, v22 row_half_mirror row_mask:0xf bank_mask:0xf
    s_nop 1
    v_add_f32_dpp v22, v22, v22 row_mirror row_mask:0xf bank_mask:0xf
    v_mul_f32 v22, 0x3b000000, v22
    v_cvt_pk_bf16_f32 v20, v20, v20
    v_lshlrev_b32 v20, 16, v20
    v_cvt_pk_bf16_f32 v22, v22, v22
    v_lshlrev_b32 v22, 16, v22
    v_add_f32 v22, 0x3727c5ac, v22
    v_cvt_pk_bf16_f32 v22, v22, v22
    v_lshlrev_b32 v22, 16, v22
    v_sqrt_f32 v22, v22
    s_nop 0
    v_cvt_pk_bf16_f32 v22, v22, v22
    v_lshlrev_b32 v22, 16, v22
    v_rcp_f32 v21, v22
    s_nop 0
    ds_bpermute_b32 v24, v2, v20
    ds_bpermute_b32 v25, v2, v21
    s_cmp_eq_u32 s81, 0
    s_cbranch_scc1 K1_q_norm
    v_sub_f32 v32, v32, v20
    v_sub_f32 v33, v33, v20
    v_cvt_pk_bf16_f32 v33, v32, v33
    v_lshlrev_b32 v32, 16, v33
    v_and_b32 v33, 0xffff0000, v33
    v_mul_f32 v32, v32, v21
    v_mul_f32 v33, v33, v21
    v_cvt_pk_bf16_f32 v33, v32, v33
    v_lshlrev_b32 v32, 16, v33
    v_and_b32 v33, 0xffff0000, v33
    v_sub_f32 v34, v34, v20
    v_sub_f32 v35, v35, v20
    v_cvt_pk_bf16_f32 v35, v34, v35
    v_lshlrev_b32 v34, 16, v35
    v_and_b32 v35, 0xffff0000, v35
    v_mul_f32 v34, v34, v21
    v_mul_f32 v35, v35, v21
    v_cvt_pk_bf16_f32 v35, v34, v35
    v_lshlrev_b32 v34, 16, v35
    v_and_b32 v35, 0xffff0000, v35
    v_sub_f32 v36, v36, v20
    v_sub_f32 v37, v37, v20
    v_cvt_pk_bf16_f32 v37, v36, v37
    v_lshlrev_b32 v36, 16, v37
    v_and_b32 v37, 0xffff0000, v37
    v_mul_f32 v36, v36, v21
    v_mul_f32 v37, v37, v21
    v_cvt_pk_bf16_f32 v37, v36, v37
    v_lshlrev_b32 v36, 16, v37
    v_and_b32 v37, 0xffff0000, v37
    v_sub_f32 v38, v38, v20
    v_sub_f32 v39, v39, v20
    v_cvt_pk_bf16_f32 v39, v38, v39
    v_lshlrev_b32 v38, 16, v39
    v_and_b32 v39, 0xffff0000, v39
    v_mul_f32 v38, v38, v21
    v_mul_f32 v39, v39, v21
    v_cvt_pk_bf16_f32 v39, v38, v39
    v_lshlrev_b32 v38, 16, v39
    v_and_b32 v39, 0xffff0000, v39
    v_sub_f32 v40, v40, v20
    v_sub_f32 v41, v41, v20
    v_cvt_pk_bf16_f32 v41, v40, v41
    v_lshlrev_b32 v40, 16, v41
    v_and_b32 v41, 0xffff0000, v41
    v_mul_f32 v40, v40, v21
    v_mul_f32 v41, v41, v21
    v_cvt_pk_bf16_f32 v41, v40, v41
    v_lshlrev_b32 v40, 16, v41
    v_and_b32 v41, 0xffff0000, v41
    v_sub_f32 v42, v42, v20
    v_sub_f32 v43, v43, v20
    v_cvt_pk_bf16_f32 v43, v42, v43
    v_lshlrev_b32 v42, 16, v43
    v_and_b32 v43, 0xffff0000, v43
    v_mul_f32 v42, v42, v21
    v_mul_f32 v43, v43, v21
    v_cvt_pk_bf16_f32 v43, v42, v43
    v_lshlrev_b32 v42, 16, v43
    v_and_b32 v43, 0xffff0000, v43
    v_sub_f32 v44, v44, v20
    v_sub_f32 v45, v45, v20
    v_cvt_pk_bf16_f32 v45, v44, v45
    v_lshlrev_b32 v44, 16, v45
    v_and_b32 v45, 0xffff0000, v45
    v_mul_f32 v44, v44, v21
    v_mul_f32 v45, v45, v21
    v_cvt_pk_bf16_f32 v45, v44, v45
    v_lshlrev_b32 v44, 16, v45
    v_and_b32 v45, 0xffff0000, v45
    v_sub_f32 v46, v46, v20
    v_sub_f32 v47, v47, v20
    v_cvt_pk_bf16_f32 v47, v46, v47
    v_lshlrev_b32 v46, 16, v47
    v_and_b32 v47, 0xffff0000, v47
    v_mul_f32 v46, v46, v21
    v_mul_f32 v47, v47, v21
    v_cvt_pk_bf16_f32 v47, v46, v47
    v_lshlrev_b32 v46, 16, v47
    v_and_b32 v47, 0xffff0000, v47
    v_sub_f32 v48, v48, v20
    v_sub_f32 v49, v49, v20
    v_cvt_pk_bf16_f32 v49, v48, v49
    v_lshlrev_b32 v48, 16, v49
    v_and_b32 v49, 0xffff0000, v49
    v_mul_f32 v48, v48, v21
    v_mul_f32 v49, v49, v21
    v_cvt_pk_bf16_f32 v49, v48, v49
    v_lshlrev_b32 v48, 16, v49
    v_and_b32 v49, 0xffff0000, v49
    v_sub_f32 v50, v50, v20
    v_sub_f32 v51, v51, v20
    v_cvt_pk_bf16_f32 v51, v50, v51
    v_lshlrev_b32 v50, 16, v51
    v_and_b32 v51, 0xffff0000, v51
    v_mul_f32 v50, v50, v21
    v_mul_f32 v51, v51, v21
    v_cvt_pk_bf16_f32 v51, v50, v51
    v_lshlrev_b32 v50, 16, v51
    v_and_b32 v51, 0xffff0000, v51
    v_sub_f32 v52, v52, v20
    v_sub_f32 v53, v53, v20
    v_cvt_pk_bf16_f32 v53, v52, v53
    v_lshlrev_b32 v52, 16, v53
    v_and_b32 v53, 0xffff0000, v53
    v_mul_f32 v52, v52, v21
    v_mul_f32 v53, v53, v21
    v_cvt_pk_bf16_f32 v53, v52, v53
    v_lshlrev_b32 v52, 16, v53
    v_and_b32 v53, 0xffff0000, v53
    v_sub_f32 v54, v54, v20
    v_sub_f32 v55, v55, v20
    v_cvt_pk_bf16_f32 v55, v54, v55
    v_lshlrev_b32 v54, 16, v55
    v_and_b32 v55, 0xffff0000, v55
    v_mul_f32 v54, v54, v21
    v_mul_f32 v55, v55, v21
    v_cvt_pk_bf16_f32 v55, v54, v55
    v_lshlrev_b32 v54, 16, v55
    v_and_b32 v55, 0xffff0000, v55
    v_sub_f32 v56, v56, v20
    v_sub_f32 v57, v57, v20
    v_cvt_pk_bf16_f32 v57, v56, v57
    v_lshlrev_b32 v56, 16, v57
    v_and_b32 v57, 0xffff0000, v57
    v_mul_f32 v56, v56, v21
    v_mul_f32 v57, v57, v21
    v_cvt_pk_bf16_f32 v57, v56, v57
    v_lshlrev_b32 v56, 16, v57
    v_and_b32 v57, 0xffff0000, v57
    v_sub_f32 v58, v58, v20
    v_sub_f32 v59, v59, v20
    v_cvt_pk_bf16_f32 v59, v58, v59
    v_lshlrev_b32 v58, 16, v59
    v_and_b32 v59, 0xffff0000, v59
    v_mul_f32 v58, v58, v21
    v_mul_f32 v59, v59, v21
    v_cvt_pk_bf16_f32 v59, v58, v59
    v_lshlrev_b32 v58, 16, v59
    v_and_b32 v59, 0xffff0000, v59
    v_sub_f32 v60, v60, v20
    v_sub_f32 v61, v61, v20
    v_cvt_pk_bf16_f32 v61, v60, v61
    v_lshlrev_b32 v60, 16, v61
    v_and_b32 v61, 0xffff0000, v61
    v_mul_f32 v60, v60, v21
    v_mul_f32 v61, v61, v21
    v_cvt_pk_bf16_f32 v61, v60, v61
    v_lshlrev_b32 v60, 16, v61
    v_and_b32 v61, 0xffff0000, v61
    v_sub_f32 v62, v62, v20
    v_sub_f32 v63, v63, v20
    v_cvt_pk_bf16_f32 v63, v62, v63
    v_lshlrev_b32 v62, 16, v63
    v_and_b32 v63, 0xffff0000, v63
    v_mul_f32 v62, v62, v21
    v_mul_f32 v63, v63, v21
    v_cvt_pk_bf16_f32 v63, v62, v63
    v_lshlrev_b32 v62, 16, v63
    v_and_b32 v63, 0xffff0000, v63
    v_add_f32 v22, v32, v33
    v_add_f32 v23, v34, v35
    v_add_f32 v22, v22, v36
    v_add_f32 v23, v23, v37
    v_add_f32 v22, v22, v38
    v_add_f32 v23, v23, v39
    v_add_f32 v22, v22, v40
    v_add_f32 v23, v23, v41
    v_add_f32 v22, v22, v42
    v_add_f32 v23, v23, v43
    v_add_f32 v22, v22, v44
    v_add_f32 v23, v23, v45
    v_add_f32 v22, v22, v46
    v_add_f32 v23, v23, v47
    v_add_f32 v22, v22, v48
    v_add_f32 v23, v23, v49
    v_add_f32 v22, v22, v50
    v_add_f32 v23, v23, v51
    v_add_f32 v22, v22, v52
    v_add_f32 v23, v23, v53
    v_add_f32 v22, v22, v54
    v_add_f32 v23, v23, v55
    v_add_f32 v22, v22, v56
    v_add_f32 v23, v23, v57
    v_add_f32 v22, v22, v58
    v_add_f32 v23, v23, v59
    v_add_f32 v22, v22, v60
    v_add_f32 v23, v23, v61
    v_add_f32 v22, v22, v62
    v_add_f32 v23, v23, v63
    v_add_f32 v22, v22, v23
    s_nop 1
    v_add_f32_dpp v22, v22, v22 quad_perm:[1,0,3,2] row_mask:0xf bank_mask:0xf
    s_nop 1
    v_add_f32_dpp v22, v22, v22 quad_perm:[2,3,0,1] row_mask:0xf bank_mask:0xf
    s_nop 1
    v_add_f32_dpp v22, v22, v22 row_half_mirror row_mask:0xf bank_mask:0xf
    s_nop 1
    v_add_f32_dpp v22, v22, v22 row_mirror row_mask:0xf bank_mask:0xf
    v_mul_f32 v20, 0x3b000000, v22
    v_sub_f32 v23, v32, v20
    v_mul_f32 v22, v23, v23
    v_sub_f32 v23, v33, v20
    v_fmac_f32 v22, v23, v23
    v_sub_f32 v23, v34, v20
    v_fmac_f32 v22, v23, v23
    v_sub_f32 v23, v35, v20
    v_fmac_f32 v22, v23, v23
    v_sub_f32 v23, v36, v20
    v_fmac_f32 v22, v23, v23
    v_sub_f32 v23, v37, v20
    v_fmac_f32 v22, v23, v23
    v_sub_f32 v23, v38, v20
    v_fmac_f32 v22, v23, v23
    v_sub_f32 v23, v39, v20
    v_fmac_f32 v22, v23, v23
    v_sub_f32 v23, v40, v20
    v_fmac_f32 v22, v23, v23
    v_sub_f32 v23, v41, v20
    v_fmac_f32 v22, v23, v23
    v_sub_f32 v23, v42, v20
    v_fmac_f32 v22, v23, v23
    v_sub_f32 v23, v43, v20
    v_fmac_f32 v22, v23, v23
    v_sub_f32 v23, v44, v20
    v_fmac_f32 v22, v23, v23
    v_sub_f32 v23, v45, v20
    v_fmac_f32 v22, v23, v23
    v_sub_f32 v23, v46, v20
    v_fmac_f32 v22, v23, v23
    v_sub_f32 v23, v47, v20
    v_fmac_f32 v22, v23, v23
    v_sub_f32 v23, v48, v20
    v_fmac_f32 v22, v23, v23
    v_sub_f32 v23, v49, v20
    v_fmac_f32 v22, v23, v23
    v_sub_f32 v23, v50, v20
    v_fmac_f32 v22, v23, v23
    v_sub_f32 v23, v51, v20
    v_fmac_f32 v22, v23, v23
    v_sub_f32 v23, v52, v20
    v_fmac_f32 v22, v23, v23
    v_sub_f32 v23, v53, v20
    v_fmac_f32 v22, v23, v23
    v_sub_f32 v23, v54, v20
    v_fmac_f32 v22, v23, v23
    v_sub_f32 v23, v55, v20
    v_fmac_f32 v22, v23, v23
    v_sub_f32 v23, v56, v20
    v_fmac_f32 v22, v23, v23
    v_sub_f32 v23, v57, v20
    v_fmac_f32 v22, v23, v23
    v_sub_f32 v23, v58, v20
    v_fmac_f32 v22, v23, v23
    v_sub_f32 v23, v59, v20
    v_fmac_f32 v22, v23, v23
    v_sub_f32 v23, v60, v20
    v_fmac_f32 v22, v23, v23
    v_sub_f32 v23, v61, v20
    v_fmac_f32 v22, v23, v23
    v_sub_f32 v23, v62, v20
    v_fmac_f32 v22, v23, v23
    v_sub_f32 v23, v63, v20
    v_fmac_f32 v22, v23, v23
    s_nop 1
    v_add_f32_dpp v22, v22, v22 quad_perm:[1,0,3,2] row_mask:0xf bank_mask:0xf
    s_nop 1
    v_add_f32_dpp v22, v22, v22 quad_perm:[2,3,0,1] row_mask:0xf bank_mask:0xf
    s_nop 1
    v_add_f32_dpp v22, v22, v22 row_half_mirror row_mask:0xf bank_mask:0xf
    s_nop 1
    v_add_f32_dpp v22, v22, v22 row_mirror row_mask:0xf bank_mask:0xf
    v_mul_f32 v22, 0x3b000000, v22
    v_cvt_pk_bf16_f32 v20, v20, v20
    v_lshlrev_b32 v20, 16, v20
    v_cvt_pk_bf16_f32 v22, v22, v22
    v_lshlrev_b32 v22, 16, v22
    v_add_f32 v22, 0x3727c5ac, v22
    v_cvt_pk_bf16_f32 v22, v22, v22
    v_lshlrev_b32 v22, 16, v22
    v_sqrt_f32 v22, v22
    s_nop 0
    v_cvt_pk_bf16_f32 v22, v22, v22
    v_lshlrev_b32 v22, 16, v22
    v_rcp_f32 v21, v22
    s_nop 0
    ds_bpermute_b32 v26, v2, v20
    ds_bpermute_b32 v27, v2, v21
    s_waitcnt vmcnt(33) lgkmcnt(0)
    v_lshlrev_b32 v22, 16, v80
    v_and_b32 v23, 0xffff0000, v80
    v_sub_f32 v22, v22, v24
    v_sub_f32 v23, v23, v24
    v_cvt_pk_bf16_f32 v23, v22, v23
    v_lshlrev_b32 v22, 16, v23
    v_and_b32 v23, 0xffff0000, v23
    v_mul_f32 v22, v22, v25
    v_mul_f32 v23, v23, v25
    v_cvt_pk_bf16_f32 v23, v22, v23
    v_lshlrev_b32 v22, 16, v23
    v_and_b32 v23, 0xffff0000, v23
    v_sub_f32 v22, v22, v26
    v_sub_f32 v23, v23, v26
    v_cvt_pk_bf16_f32 v23, v22, v23
    v_lshlrev_b32 v22, 16, v23
    v_and_b32 v23, 0xffff0000, v23
    v_mul_f32 v22, v22, v27
    v_mul_f32 v23, v23, v27
    v_cvt_pk_bf16_f32 v80, v22, v23
    v_lshlrev_b32 v22, 16, v81
    v_and_b32 v23, 0xffff0000, v81
    v_sub_f32 v22, v22, v24
    v_sub_f32 v23, v23, v24
    v_cvt_pk_bf16_f32 v23, v22, v23
    v_lshlrev_b32 v22, 16, v23
    v_and_b32 v23, 0xffff0000, v23
    v_mul_f32 v22, v22, v25
    v_mul_f32 v23, v23, v25
    v_cvt_pk_bf16_f32 v23, v22, v23
    v_lshlrev_b32 v22, 16, v23
    v_and_b32 v23, 0xffff0000, v23
    v_sub_f32 v22, v22, v26
    v_sub_f32 v23, v23, v26
    v_cvt_pk_bf16_f32 v23, v22, v23
    v_lshlrev_b32 v22, 16, v23
    v_and_b32 v23, 0xffff0000, v23
    v_mul_f32 v22, v22, v27
    v_mul_f32 v23, v23, v27
    v_cvt_pk_bf16_f32 v81, v22, v23
    v_lshlrev_b32 v22, 16, v82
    v_and_b32 v23, 0xffff0000, v82
    v_sub_f32 v22, v22, v24
    v_sub_f32 v23, v23, v24
    v_cvt_pk_bf16_f32 v23, v22, v23
    v_lshlrev_b32 v22, 16, v23
    v_and_b32 v23, 0xffff0000, v23
    v_mul_f32 v22, v22, v25
    v_mul_f32 v23, v23, v25
    v_cvt_pk_bf16_f32 v23, v22, v23
    v_lshlrev_b32 v22, 16, v23
    v_and_b32 v23, 0xffff0000, v23
    v_sub_f32 v22, v22, v26
    v_sub_f32 v23, v23, v26
    v_cvt_pk_bf16_f32 v23, v22, v23
    v_lshlrev_b32 v22, 16, v23
    v_and_b32 v23, 0xffff0000, v23
    v_mul_f32 v22, v22, v27
    v_mul_f32 v23, v23, v27
    v_cvt_pk_bf16_f32 v82, v22, v23
    v_lshlrev_b32 v22, 16, v83
    v_and_b32 v23, 0xffff0000, v83
    v_sub_f32 v22, v22, v24
    v_sub_f32 v23, v23, v24
    v_cvt_pk_bf16_f32 v23, v22, v23
    v_lshlrev_b32 v22, 16, v23
    v_and_b32 v23, 0xffff0000, v23
    v_mul_f32 v22, v22, v25
    v_mul_f32 v23, v23, v25
    v_cvt_pk_bf16_f32 v23, v22, v23
    v_lshlrev_b32 v22, 16, v23
    v_and_b32 v23, 0xffff0000, v23
    v_sub_f32 v22, v22, v26
    v_sub_f32 v23, v23, v26
    v_cvt_pk_bf16_f32 v23, v22, v23
    v_lshlrev_b32 v22, 16, v23
    v_and_b32 v23, 0xffff0000, v23
    v_mul_f32 v22, v22, v27
    v_mul_f32 v23, v23, v27
    v_cvt_pk_bf16_f32 v83, v22, v23
    v_lshlrev_b32 v22, 16, v84
    v_and_b32 v23, 0xffff0000, v84
    v_sub_f32 v22, v22, v24
    v_sub_f32 v23, v23, v24
    v_cvt_pk_bf16_f32 v23, v22, v23
    v_lshlrev_b32 v22, 16, v23
    v_and_b32 v23, 0xffff0000, v23
    v_mul_f32 v22, v22, v25
    v_mul_f32 v23, v23, v25
    v_cvt_pk_bf16_f32 v23, v22, v23
    v_lshlrev_b32 v22, 16, v23
    v_and_b32 v23, 0xffff0000, v23
    v_sub_f32 v22, v22, v26
    v_sub_f32 v23, v23, v26
    v_cvt_pk_bf16_f32 v23, v22, v23
    v_lshlrev_b32 v22, 16, v23
    v_and_b32 v23, 0xffff0000, v23
    v_mul_f32 v22, v22, v27
    v_mul_f32 v23, v23, v27
    v_cvt_pk_bf16_f32 v84, v22, v23
    v_lshlrev_b32 v22, 16, v85
    v_and_b32 v23, 0xffff0000, v85
    v_sub_f32 v22, v22, v24
    v_sub_f32 v23, v23, v24
    v_cvt_pk_bf16_f32 v23, v22, v23
    v_lshlrev_b32 v22, 16, v23
    v_and_b32 v23, 0xffff0000, v23
    v_mul_f32 v22, v22, v25
    v_mul_f32 v23, v23, v25
    v_cvt_pk_bf16_f32 v23, v22, v23
    v_lshlrev_b32 v22, 16, v23
    v_and_b32 v23, 0xffff0000, v23
    v_sub_f32 v22, v22, v26
    v_sub_f32 v23, v23, v26
    v_cvt_pk_bf16_f32 v23, v22, v23
    v_lshlrev_b32 v22, 16, v23
    v_and_b32 v23, 0xffff0000, v23
    v_mul_f32 v22, v22, v27
    v_mul_f32 v23, v23, v27
    v_cvt_pk_bf16_f32 v85, v22, v23
    v_lshlrev_b32 v22, 16, v86
    v_and_b32 v23, 0xffff0000, v86
    v_sub_f32 v22, v22, v24
    v_sub_f32 v23, v23, v24
    v_cvt_pk_bf16_f32 v23, v22, v23
    v_lshlrev_b32 v22, 16, v23
    v_and_b32 v23, 0xffff0000, v23
    v_mul_f32 v22, v22, v25
    v_mul_f32 v23, v23, v25
    v_cvt_pk_bf16_f32 v23, v22, v23
    v_lshlrev_b32 v22, 16, v23
    v_and_b32 v23, 0xffff0000, v23
    v_sub_f32 v22, v22, v26
    v_sub_f32 v23, v23, v26
    v_cvt_pk_bf16_f32 v23, v22, v23
    v_lshlrev_b32 v22, 16, v23
    v_and_b32 v23, 0xffff0000, v23
    v_mul_f32 v22, v22, v27
    v_mul_f32 v23, v23, v27
    v_cvt_pk_bf16_f32 v86, v22, v23
    v_lshlrev_b32 v22, 16, v87
    v_and_b32 v23, 0xffff0000, v87
    v_sub_f32 v22, v22, v24
    v_sub_f32 v23, v23, v24
    v_cvt_pk_bf16_f32 v23, v22, v23
    v_lshlrev_b32 v22, 16, v23
    v_and_b32 v23, 0xffff0000, v23
    v_mul_f32 v22, v22, v25
    v_mul_f32 v23, v23, v25
    v_cvt_pk_bf16_f32 v23, v22, v23
    v_lshlrev_b32 v22, 16, v23
    v_and_b32 v23, 0xffff0000, v23
    v_sub_f32 v22, v22, v26
    v_sub_f32 v23, v23, v26
    v_cvt_pk_bf16_f32 v23, v22, v23
    v_lshlrev_b32 v22, 16, v23
    v_and_b32 v23, 0xffff0000, v23
    v_mul_f32 v22, v22, v27
    v_mul_f32 v23, v23, v27
    v_cvt_pk_bf16_f32 v87, v22, v23
    v_lshlrev_b32 v22, 16, v88
    v_and_b32 v23, 0xffff0000, v88
    v_sub_f32 v22, v22, v24
    v_sub_f32 v23, v23, v24
    v_cvt_pk_bf16_f32 v23, v22, v23
    v_lshlrev_b32 v22, 16, v23
    v_and_b32 v23, 0xffff0000, v23
    v_mul_f32 v22, v22, v25
    v_mul_f32 v23, v23, v25
    v_cvt_pk_bf16_f32 v23, v22, v23
    v_lshlrev_b32 v22, 16, v23
    v_and_b32 v23, 0xffff0000, v23
    v_sub_f32 v22, v22, v26
    v_sub_f32 v23, v23, v26
    v_cvt_pk_bf16_f32 v23, v22, v23
    v_lshlrev_b32 v22, 16, v23
    v_and_b32 v23, 0xffff0000, v23
    v_mul_f32 v22, v22, v27
    v_mul_f32 v23, v23, v27
    v_cvt_pk_bf16_f32 v88, v22, v23
    v_lshlrev_b32 v22, 16, v89
    v_and_b32 v23, 0xffff0000, v89
    v_sub_f32 v22, v22, v24
    v_sub_f32 v23, v23, v24
    v_cvt_pk_bf16_f32 v23, v22, v23
    v_lshlrev_b32 v22, 16, v23
    v_and_b32 v23, 0xffff0000, v23
    v_mul_f32 v22, v22, v25
    v_mul_f32 v23, v23, v25
    v_cvt_pk_bf16_f32 v23, v22, v23
    v_lshlrev_b32 v22, 16, v23
    v_and_b32 v23, 0xffff0000, v23
    v_sub_f32 v22, v22, v26
    v_sub_f32 v23, v23, v26
    v_cvt_pk_bf16_f32 v23, v22, v23
    v_lshlrev_b32 v22, 16, v23
    v_and_b32 v23, 0xffff0000, v23
    v_mul_f32 v22, v22, v27
    v_mul_f32 v23, v23, v27
    v_cvt_pk_bf16_f32 v89, v22, v23
    v_lshlrev_b32 v22, 16, v90
    v_and_b32 v23, 0xffff0000, v90
    v_sub_f32 v22, v22, v24
    v_sub_f32 v23, v23, v24
    v_cvt_pk_bf16_f32 v23, v22, v23
    v_lshlrev_b32 v22, 16, v23
    v_and_b32 v23, 0xffff0000, v23
    v_mul_f32 v22, v22, v25
    v_mul_f32 v23, v23, v25
    v_cvt_pk_bf16_f32 v23, v22, v23
    v_lshlrev_b32 v22, 16, v23
    v_and_b32 v23, 0xffff0000, v23
    v_sub_f32 v22, v22, v26
    v_sub_f32 v23, v23, v26
    v_cvt_pk_bf16_f32 v23, v22, v23
    v_lshlrev_b32 v22, 16, v23
    v_and_b32 v23, 0xffff0000, v23
    v_mul_f32 v22, v22, v27
    v_mul_f32 v23, v23, v27
    v_cvt_pk_bf16_f32 v90, v22, v23
    v_lshlrev_b32 v22, 16, v91
    v_and_b32 v23, 0xffff0000, v91
    v_sub_f32 v22, v22, v24
    v_sub_f32 v23, v23, v24
    v_cvt_pk_bf16_f32 v23, v22, v23
    v_lshlrev_b32 v22, 16, v23
    v_and_b32 v23, 0xffff0000, v23
    v_mul_f32 v22, v22, v25
    v_mul_f32 v23, v23, v25
    v_cvt_pk_bf16_f32 v23, v22, v23
    v_lshlrev_b32 v22, 16, v23
    v_and_b32 v23, 0xffff0000, v23
    v_sub_f32 v22, v22, v26
    v_sub_f32 v23, v23, v26
    v_cvt_pk_bf16_f32 v23, v22, v23
    v_lshlrev_b32 v22, 16, v23
    v_and_b32 v23, 0xffff0000, v23
    v_mul_f32 v22, v22, v27
    v_mul_f32 v23, v23, v27
    v_cvt_pk_bf16_f32 v91, v22, v23
    v_lshlrev_b32 v22, 16, v92
    v_and_b32 v23, 0xffff0000, v92
    v_sub_f32 v22, v22, v24
    v_sub_f32 v23, v23, v24
    v_cvt_pk_bf16_f32 v23, v22, v23
    v_lshlrev_b32 v22, 16, v23
    v_and_b32 v23, 0xffff0000, v23
    v_mul_f32 v22, v22, v25
    v_mul_f32 v23, v23, v25
    v_cvt_pk_bf16_f32 v23, v22, v23
    v_lshlrev_b32 v22, 16, v23
    v_and_b32 v23, 0xffff0000, v23
    v_sub_f32 v22, v22, v26
    v_sub_f32 v23, v23, v26
    v_cvt_pk_bf16_f32 v23, v22, v23
    v_lshlrev_b32 v22, 16, v23
    v_and_b32 v23, 0xffff0000, v23
    v_mul_f32 v22, v22, v27
    v_mul_f32 v23, v23, v27
    v_cvt_pk_bf16_f32 v92, v22, v23
    v_lshlrev_b32 v22, 16, v93
    v_and_b32 v23, 0xffff0000, v93
    v_sub_f32 v22, v22, v24
    v_sub_f32 v23, v23, v24
    v_cvt_pk_bf16_f32 v23, v22, v23
    v_lshlrev_b32 v22, 16, v23
    v_and_b32 v23, 0xffff0000, v23
    v_mul_f32 v22, v22, v25
    v_mul_f32 v23, v23, v25
    v_cvt_pk_bf16_f32 v23, v22, v23
    v_lshlrev_b32 v22, 16, v23
    v_and_b32 v23, 0xffff0000, v23
    v_sub_f32 v22, v22, v26
    v_sub_f32 v23, v23, v26
    v_cvt_pk_bf16_f32 v23, v22, v23
    v_lshlrev_b32 v22, 16, v23
    v_and_b32 v23, 0xffff0000, v23
    v_mul_f32 v22, v22, v27
    v_mul_f32 v23, v23, v27
    v_cvt_pk_bf16_f32 v93, v22, v23
    v_lshlrev_b32 v22, 16, v94
    v_and_b32 v23, 0xffff0000, v94
    v_sub_f32 v22, v22, v24
    v_sub_f32 v23, v23, v24
    v_cvt_pk_bf16_f32 v23, v22, v23
    v_lshlrev_b32 v22, 16, v23
    v_and_b32 v23, 0xffff0000, v23
    v_mul_f32 v22, v22, v25
    v_mul_f32 v23, v23, v25
    v_cvt_pk_bf16_f32 v23, v22, v23
    v_lshlrev_b32 v22, 16, v23
    v_and_b32 v23, 0xffff0000, v23
    v_sub_f32 v22, v22, v26
    v_sub_f32 v23, v23, v26
    v_cvt_pk_bf16_f32 v23, v22, v23
    v_lshlrev_b32 v22, 16, v23
    v_and_b32 v23, 0xffff0000, v23
    v_mul_f32 v22, v22, v27
    v_mul_f32 v23, v23, v27
    v_cvt_pk_bf16_f32 v94, v22, v23
    v_lshlrev_b32 v22, 16, v95
    v_and_b32 v23, 0xffff0000, v95
    v_sub_f32 v22, v22, v24
    v_sub_f32 v23, v23, v24
    v_cvt_pk_bf16_f32 v23, v22, v23
    v_lshlrev_b32 v22, 16, v23
    v_and_b32 v23, 0xffff0000, v23
    v_mul_f32 v22, v22, v25
    v_mul_f32 v23, v23, v25
    v_cvt_pk_bf16_f32 v23, v22, v23
    v_lshlrev_b32 v22, 16, v23
    v_and_b32 v23, 0xffff0000, v23
    v_sub_f32 v22, v22, v26
    v_sub_f32 v23, v23, v26
    v_cvt_pk_bf16_f32 v23, v22, v23
    v_lshlrev_b32 v22, 16, v23
    v_and_b32 v23, 0xffff0000, v23
    v_mul_f32 v22, v22, v27
    v_mul_f32 v23, v23, v27
    v_cvt_pk_bf16_f32 v95, v22, v23
    s_branch K1_norm_done
K1_q_norm:
    s_waitcnt vmcnt(33) lgkmcnt(0)
    v_lshlrev_b32 v22, 16, v80
    v_and_b32 v23, 0xffff0000, v80
    v_sub_f32 v22, v22, v24
    v_sub_f32 v23, v23, v24
    v_cvt_pk_bf16_f32 v23, v22, v23
    v_lshlrev_b32 v22, 16, v23
    v_and_b32 v23, 0xffff0000, v23
    v_mul_f32 v22, v22, v25
    v_mul_f32 v23, v23, v25
    v_cvt_pk_bf16_f32 v80, v22, v23
    v_lshlrev_b32 v22, 16, v81
    v_and_b32 v23, 0xffff0000, v81
    v_sub_f32 v22, v22, v24
    v_sub_f32 v23, v23, v24
    v_cvt_pk_bf16_f32 v23, v22, v23
    v_lshlrev_b32 v22, 16, v23
    v_and_b32 v23, 0xffff0000, v23
    v_mul_f32 v22, v22, v25
    v_mul_f32 v23, v23, v25
    v_cvt_pk_bf16_f32 v81, v22, v23
    v_lshlrev_b32 v22, 16, v82
    v_and_b32 v23, 0xffff0000, v82
    v_sub_f32 v22, v22, v24
    v_sub_f32 v23, v23, v24
    v_cvt_pk_bf16_f32 v23, v22, v23
    v_lshlrev_b32 v22, 16, v23
    v_and_b32 v23, 0xffff0000, v23
    v_mul_f32 v22, v22, v25
    v_mul_f32 v23, v23, v25
    v_cvt_pk_bf16_f32 v82, v22, v23
    v_lshlrev_b32 v22, 16, v83
    v_and_b32 v23, 0xffff0000, v83
    v_sub_f32 v22, v22, v24
    v_sub_f32 v23, v23, v24
    v_cvt_pk_bf16_f32 v23, v22, v23
    v_lshlrev_b32 v22, 16, v23
    v_and_b32 v23, 0xffff0000, v23
    v_mul_f32 v22, v22, v25
    v_mul_f32 v23, v23, v25
    v_cvt_pk_bf16_f32 v83, v22, v23
    v_lshlrev_b32 v22, 16, v84
    v_and_b32 v23, 0xffff0000, v84
    v_sub_f32 v22, v22, v24
    v_sub_f32 v23, v23, v24
    v_cvt_pk_bf16_f32 v23, v22, v23
    v_lshlrev_b32 v22, 16, v23
    v_and_b32 v23, 0xffff0000, v23
    v_mul_f32 v22, v22, v25
    v_mul_f32 v23, v23, v25
    v_cvt_pk_bf16_f32 v84, v22, v23
    v_lshlrev_b32 v22, 16, v85
    v_and_b32 v23, 0xffff0000, v85
    v_sub_f32 v22, v22, v24
    v_sub_f32 v23, v23, v24
    v_cvt_pk_bf16_f32 v23, v22, v23
    v_lshlrev_b32 v22, 16, v23
    v_and_b32 v23, 0xffff0000, v23
    v_mul_f32 v22, v22, v25
    v_mul_f32 v23, v23, v25
    v_cvt_pk_bf16_f32 v85, v22, v23
    v_lshlrev_b32 v22, 16, v86
    v_and_b32 v23, 0xffff0000, v86
    v_sub_f32 v22, v22, v24
    v_sub_f32 v23, v23, v24
    v_cvt_pk_bf16_f32 v23, v22, v23
    v_lshlrev_b32 v22, 16, v23
    v_and_b32 v23, 0xffff0000, v23
    v_mul_f32 v22, v22, v25
    v_mul_f32 v23, v23, v25
    v_cvt_pk_bf16_f32 v86, v22, v23
    v_lshlrev_b32 v22, 16, v87
    v_and_b32 v23, 0xffff0000, v87
    v_sub_f32 v22, v22, v24
    v_sub_f32 v23, v23, v24
    v_cvt_pk_bf16_f32 v23, v22, v23
    v_lshlrev_b32 v22, 16, v23
    v_and_b32 v23, 0xffff0000, v23
    v_mul_f32 v22, v22, v25
    v_mul_f32 v23, v23, v25
    v_cvt_pk_bf16_f32 v87, v22, v23
    v_lshlrev_b32 v22, 16, v88
    v_and_b32 v23, 0xffff0000, v88
    v_sub_f32 v22, v22, v24
    v_sub_f32 v23, v23, v24
    v_cvt_pk_bf16_f32 v23, v22, v23
    v_lshlrev_b32 v22, 16, v23
    v_and_b32 v23, 0xffff0000, v23
    v_mul_f32 v22, v22, v25
    v_mul_f32 v23, v23, v25
    v_cvt_pk_bf16_f32 v88, v22, v23
    v_lshlrev_b32 v22, 16, v89
    v_and_b32 v23, 0xffff0000, v89
    v_sub_f32 v22, v22, v24
    v_sub_f32 v23, v23, v24
    v_cvt_pk_bf16_f32 v23, v22, v23
    v_lshlrev_b32 v22, 16, v23
    v_and_b32 v23, 0xffff0000, v23
    v_mul_f32 v22, v22, v25
    v_mul_f32 v23, v23, v25
    v_cvt_pk_bf16_f32 v89, v22, v23
    v_lshlrev_b32 v22, 16, v90
    v_and_b32 v23, 0xffff0000, v90
    v_sub_f32 v22, v22, v24
    v_sub_f32 v23, v23, v24
    v_cvt_pk_bf16_f32 v23, v22, v23
    v_lshlrev_b32 v22, 16, v23
    v_and_b32 v23, 0xffff0000, v23
    v_mul_f32 v22, v22, v25
    v_mul_f32 v23, v23, v25
    v_cvt_pk_bf16_f32 v90, v22, v23
    v_lshlrev_b32 v22, 16, v91
    v_and_b32 v23, 0xffff0000, v91
    v_sub_f32 v22, v22, v24
    v_sub_f32 v23, v23, v24
    v_cvt_pk_bf16_f32 v23, v22, v23
    v_lshlrev_b32 v22, 16, v23
    v_and_b32 v23, 0xffff0000, v23
    v_mul_f32 v22, v22, v25
    v_mul_f32 v23, v23, v25
    v_cvt_pk_bf16_f32 v91, v22, v23
    v_lshlrev_b32 v22, 16, v92
    v_and_b32 v23, 0xffff0000, v92
    v_sub_f32 v22, v22, v24
    v_sub_f32 v23, v23, v24
    v_cvt_pk_bf16_f32 v23, v22, v23
    v_lshlrev_b32 v22, 16, v23
    v_and_b32 v23, 0xffff0000, v23
    v_mul_f32 v22, v22, v25
    v_mul_f32 v23, v23, v25
    v_cvt_pk_bf16_f32 v92, v22, v23
    v_lshlrev_b32 v22, 16, v93
    v_and_b32 v23, 0xffff0000, v93
    v_sub_f32 v22, v22, v24
    v_sub_f32 v23, v23, v24
    v_cvt_pk_bf16_f32 v23, v22, v23
    v_lshlrev_b32 v22, 16, v23
    v_and_b32 v23, 0xffff0000, v23
    v_mul_f32 v22, v22, v25
    v_mul_f32 v23, v23, v25
    v_cvt_pk_bf16_f32 v93, v22, v23
    v_lshlrev_b32 v22, 16, v94
    v_and_b32 v23, 0xffff0000, v94
    v_sub_f32 v22, v22, v24
    v_sub_f32 v23, v23, v24
    v_cvt_pk_bf16_f32 v23, v22, v23
    v_lshlrev_b32 v22, 16, v23
    v_and_b32 v23, 0xffff0000, v23
    v_mul_f32 v22, v22, v25
    v_mul_f32 v23, v23, v25
    v_cvt_pk_bf16_f32 v94, v22, v23
    v_lshlrev_b32 v22, 16, v95
    v_and_b32 v23, 0xffff0000, v95
    v_sub_f32 v22, v22, v24
    v_sub_f32 v23, v23, v24
    v_cvt_pk_bf16_f32 v23, v22, v23
    v_lshlrev_b32 v22, 16, v23
    v_and_b32 v23, 0xffff0000, v23
    v_mul_f32 v22, v22, v25
    v_mul_f32 v23, v23, v25
    v_cvt_pk_bf16_f32 v95, v22, v23
K1_norm_done:
    s_waitcnt vmcnt(25)
    v_perm_b32 v32, v100, v96, s40
    v_perm_b32 v33, v108, v104, s40
    v_perm_b32 v34, v116, v112, s40
    v_perm_b32 v35, v124, v120, s40
    v_perm_b32 v36, v100, v96, s41
    v_perm_b32 v37, v108, v104, s41
    v_perm_b32 v38, v116, v112, s41
    v_perm_b32 v39, v124, v120, s41
    v_perm_b32 v40, v101, v97, s40
    v_perm_b32 v41, v109, v105, s40
    v_perm_b32 v42, v117, v113, s40
    v_perm_b32 v43, v125, v121, s40
    v_perm_b32 v44, v101, v97, s41
    v_perm_b32 v45, v109, v105, s41
    v_perm_b32 v46, v117, v113, s41
    v_perm_b32 v47, v125, v121, s41
    v_perm_b32 v48, v102, v98, s40
    v_perm_b32 v49, v110, v106, s40
    v_perm_b32 v50, v118, v114, s40
    v_perm_b32 v51, v126, v122, s40
    v_perm_b32 v52, v102, v98, s41
    v_perm_b32 v53, v110, v106, s41
    v_perm_b32 v54, v118, v114, s41
    v_perm_b32 v55, v126, v122, s41
    v_perm_b32 v56, v103, v99, s40
    v_perm_b32 v57, v111, v107, s40
    v_perm_b32 v58, v119, v115, s40
    v_perm_b32 v59, v127, v123, s40
    v_perm_b32 v60, v103, v99, s41
    v_perm_b32 v61, v111, v107, s41
    v_perm_b32 v62, v119, v115, s41
    v_perm_b32 v63, v127, v123, s41
    s_nop 1
    v_mfma_f32_16x16x32_bf16 v[64:67], v[80:83], v[32:35], 0
    v_mfma_f32_16x16x32_bf16 v[68:71], v[80:83], v[36:39], 0
    v_mfma_f32_16x16x32_bf16 v[72:75], v[80:83], v[40:43], 0
    v_mfma_f32_16x16x32_bf16 v[76:79], v[80:83], v[44:47], 0
    v_mfma_f32_16x16x32_bf16 v[4:7], v[80:83], v[48:51], 0
    v_mfma_f32_16x16x32_bf16 v[8:11], v[80:83], v[52:55], 0
    v_mfma_f32_16x16x32_bf16 v[12:15], v[80:83], v[56:59], 0
    v_mfma_f32_16x16x32_bf16 v[16:19], v[80:83], v[60:63], 0
    s_nop 3
    s_waitcnt vmcnt(17)
    v_perm_b32 v32, v132, v128, s40
    v_perm_b32 v33, v140, v136, s40
    v_perm_b32 v34, v148, v144, s40
    v_perm_b32 v35, v156, v152, s40
    v_perm_b32 v36, v132, v128, s41
    v_perm_b32 v37, v140, v136, s41
    v_perm_b32 v38, v148, v144, s41
    v_perm_b32 v39, v156, v152, s41
    v_perm_b32 v40, v133, v129, s40
    v_perm_b32 v41, v141, v137, s40
    v_perm_b32 v42, v149, v145, s40
    v_perm_b32 v43, v157, v153, s40
    v_perm_b32 v44, v133, v129, s41
    v_perm_b32 v45, v141, v137, s41
    v_perm_b32 v46, v149, v145, s41
    v_perm_b32 v47, v157, v153, s41
    v_perm_b32 v48, v134, v130, s40
    v_perm_b32 v49, v142, v138, s40
    v_perm_b32 v50, v150, v146, s40
    v_perm_b32 v51, v158, v154, s40
    v_perm_b32 v52, v134, v130, s41
    v_perm_b32 v53, v142, v138, s41
    v_perm_b32 v54, v150, v146, s41
    v_perm_b32 v55, v158, v154, s41
    v_perm_b32 v56, v135, v131, s40
    v_perm_b32 v57, v143, v139, s40
    v_perm_b32 v58, v151, v147, s40
    v_perm_b32 v59, v159, v155, s40
    v_perm_b32 v60, v135, v131, s41
    v_perm_b32 v61, v143, v139, s41
    v_perm_b32 v62, v151, v147, s41
    v_perm_b32 v63, v159, v155, s41
    s_nop 1
    v_mfma_f32_16x16x32_bf16 v[64:67], v[84:87], v[32:35], v[64:67]
    v_mfma_f32_16x16x32_bf16 v[68:71], v[84:87], v[36:39], v[68:71]
    v_mfma_f32_16x16x32_bf16 v[72:75], v[84:87], v[40:43], v[72:75]
    v_mfma_f32_16x16x32_bf16 v[76:79], v[84:87], v[44:47], v[76:79]
    v_mfma_f32_16x16x32_bf16 v[4:7], v[84:87], v[48:51], v[4:7]
    v_mfma_f32_16x16x32_bf16 v[8:11], v[84:87], v[52:55], v[8:11]
    v_mfma_f32_16x16x32_bf16 v[12:15], v[84:87], v[56:59], v[12:15]
    v_mfma_f32_16x16x32_bf16 v[16:19], v[84:87], v[60:63], v[16:19]
    s_nop 3
    s_waitcnt vmcnt(9)
    v_perm_b32 v32, v164, v160, s40
    v_perm_b32 v33, v172, v168, s40
    v_perm_b32 v34, v180, v176, s40
    v_perm_b32 v35, v188, v184, s40
    v_perm_b32 v36, v164, v160, s41
    v_perm_b32 v37, v172, v168, s41
    v_perm_b32 v38, v180, v176, s41
    v_perm_b32 v39, v188, v184, s41
    v_perm_b32 v40, v165, v161, s40
    v_perm_b32 v41, v173, v169, s40
    v_perm_b32 v42, v181, v177, s40
    v_perm_b32 v43, v189, v185, s40
    v_perm_b32 v44, v165, v161, s41
    v_perm_b32 v45, v173, v169, s41
    v_perm_b32 v46, v181, v177, s41
    v_perm_b32 v47, v189, v185, s41
    v_perm_b32 v48, v166, v162, s40
    v_perm_b32 v49, v174, v170, s40
    v_perm_b32 v50, v182, v178, s40
    v_perm_b32 v51, v190, v186, s40
    v_perm_b32 v52, v166, v162, s41
    v_perm_b32 v53, v174, v170, s41
    v_perm_b32 v54, v182, v178, s41
    v_perm_b32 v55, v190, v186, s41
    v_perm_b32 v56, v167, v163, s40
    v_perm_b32 v57, v175, v171, s40
    v_perm_b32 v58, v183, v179, s40
    v_perm_b32 v59, v191, v187, s40
    v_perm_b32 v60, v167, v163, s41
    v_perm_b32 v61, v175, v171, s41
    v_perm_b32 v62, v183, v179, s41
    v_perm_b32 v63, v191, v187, s41
    s_nop 1
    v_mfma_f32_16x16x32_bf16 v[64:67], v[88:91], v[32:35], v[64:67]
    v_mfma_f32_16x16x32_bf16 v[68:71], v[88:91], v[36:39], v[68:71]
    v_mfma_f32_16x16x32_bf16 v[72:75], v[88:91], v[40:43], v[72:75]
    v_mfma_f32_16x16x32_bf16 v[76:79], v[88:91], v[44:47], v[76:79]
    v_mfma_f32_16x16x32_bf16 v[4:7], v[88:91], v[48:51], v[4:7]
    v_mfma_f32_16x16x32_bf16 v[8:11], v[88:91], v[52:55], v[8:11]
    v_mfma_f32_16x16x32_bf16 v[12:15], v[88:91], v[56:59], v[12:15]
    v_mfma_f32_16x16x32_bf16 v[16:19], v[88:91], v[60:63], v[16:19]
    s_nop 3
    s_waitcnt vmcnt(1)
    v_perm_b32 v32, v196, v192, s40
    v_perm_b32 v33, v204, v200, s40
    v_perm_b32 v34, v212, v208, s40
    v_perm_b32 v35, v220, v216, s40
    v_perm_b32 v36, v196, v192, s41
    v_perm_b32 v37, v204, v200, s41
    v_perm_b32 v38, v212, v208, s41
    v_perm_b32 v39, v220, v216, s41
    v_perm_b32 v40, v197, v193, s40
    v_perm_b32 v41, v205, v201, s40
    v_perm_b32 v42, v213, v209, s40
    v_perm_b32 v43, v221, v217, s40
    v_perm_b32 v44, v197, v193, s41
    v_perm_b32 v45, v205, v201, s41
    v_perm_b32 v46, v213, v209, s41
    v_perm_b32 v47, v221, v217, s41
    v_perm_b32 v48, v198, v194, s40
    v_perm_b32 v49, v206, v202, s40
    v_perm_b32 v50, v214, v210, s40
    v_perm_b32 v51, v222, v218, s40
    v_perm_b32 v52, v198, v194, s41
    v_perm_b32 v53, v206, v202, s41
    v_perm_b32 v54, v214, v210, s41
    v_perm_b32 v55, v222, v218, s41
    v_perm_b32 v56, v199, v195, s40
    v_perm_b32 v57, v207, v203, s40
    v_perm_b32 v58, v215, v211, s40
    v_perm_b32 v59, v223, v219, s40
    v_perm_b32 v60, v199, v195, s41
    v_perm_b32 v61, v207, v203, s41
    v_perm_b32 v62, v215, v211, s41
    v_perm_b32 v63, v223, v219, s41
    s_nop 1
    v_mfma_f32_16x16x32_bf16 v[64:67], v[92:95], v[32:35], v[64:67]
    v_mfma_f32_16x16x32_bf16 v[68:71], v[92:95], v[36:39], v[68:71]
    v_mfma_f32_16x16x32_bf16 v[72:75], v[92:95], v[40:43], v[72:75]
    v_mfma_f32_16x16x32_bf16 v[76:79], v[92:95], v[44:47], v[76:79]
    v_mfma_f32_16x16x32_bf16 v[4:7], v[92:95], v[48:51], v[4:7]
    v_mfma_f32_16x16x32_bf16 v[8:11], v[92:95], v[52:55], v[8:11]
    v_mfma_f32_16x16x32_bf16 v[12:15], v[92:95], v[56:59], v[12:15]
    v_mfma_f32_16x16x32_bf16 v[16:19], v[92:95], v[60:63], v[16:19]
    s_nop 3
    s_nop 7
    s_mov_b64 exec, s[82:83]
    ds_write2_b32 v227, v64, v68 offset0:0 offset1:1
    ds_write2_b32 v227, v72, v76 offset0:2 offset1:3
    ds_write2_b32 v227, v4, v8 offset0:4 offset1:5
    ds_write2_b32 v227, v12, v16 offset0:6 offset1:7
    ds_write2_b32 v227, v65, v69 offset0:32 offset1:33
    ds_write2_b32 v227, v73, v77 offset0:34 offset1:35
    ds_write2_b32 v227, v5, v9 offset0:36 offset1:37
    ds_write2_b32 v227, v13, v17 offset0:38 offset1:39
    ds_write2_b32 v227, v66, v70 offset0:64 offset1:65
    ds_write2_b32 v227, v74, v78 offset0:66 offset1:67
    ds_write2_b32 v227, v6, v10 offset0:68 offset1:69
    ds_write2_b32 v227, v14, v18 offset0:70 offset1:71
    ds_write2_b32 v227, v67, v71 offset0:96 offset1:97
    ds_write2_b32 v227, v75, v79 offset0:98 offset1:99
    ds_write2_b32 v227, v7, v11 offset0:100 offset1:101
    ds_write2_b32 v227, v15, v19 offset0:102 offset1:103
    s_mov_b64 exec, -1
    v_lshlrev_b32 v1, 3, v3
    s_waitcnt lgkmcnt(0)
    ds_read_b64 v[32:33], v1 offset:0
    ds_read_b64 v[34:35], v1 offset:512
    ds_read_b64 v[36:37], v1 offset:1024
    ds_read_b64 v[38:39], v1 offset:1536
    s_waitcnt lgkmcnt(0)
    v_add_f32 v32, v32, v34
    v_add_f32 v33, v33, v35
    v_add_f32 v36, v36, v38
    v_add_f32 v37, v37, v39
    v_add_f32 v32, v32, v36
    v_add_f32 v33, v33, v37
    v_lshrrev_b32 v2, 4, v3
    v_and_b32 v22, 15, v3
    s_cmp_eq_u32 s81, 0
    s_cbranch_scc1 K1_qstore
    v_cvt_pk_bf16_f32 v32, v32, v32
    v_lshlrev_b32 v32, 16, v32
    v_cvt_pk_bf16_f32 v33, v33, v33
    v_lshlrev_b32 v33, 16, v33
    s_waitcnt vmcnt(0)
    v_lshlrev_b32 v34, 16, v226
    v_and_b32 v35, 0xffff0000, v226
    v_add_f32 v32, v32, v34
    v_add_f32 v33, v33, v35
    v_cvt_pk_bf16_f32 v32, v32, v32
    v_lshlrev_b32 v32, 16, v32
    v_cvt_pk_bf16_f32 v33, v33, v33
    v_lshlrev_b32 v33, 16, v33
    s_mov_b32 s84, 0x3d372713
    s_mov_b32 s85, 0xc0135761
    v_mul_f32 v34, v32, v32
    v_mul_f32 v34, v34, v32
    v_fma_f32 v34, v34, s84, v32
    v_mul_f32 v34, s85, v34
    v_exp_f32 v34, v34
    s_nop 0
    v_add_f32 v34, 1.0, v34
    v_rcp_f32 v34, v34
    s_nop 0
    v_mul_f32 v32, v32, v34
    v_mul_f32 v34, v33, v33
    v_mul_f32 v34, v34, v33
    v_fma_f32 v34, v34, s84, v33
    v_mul_f32 v34, s85, v34
    v_exp_f32 v34, v34
    s_nop 0
    v_add_f32 v34, 1.0, v34
    v_rcp_f32 v34, v34
    s_nop 0
    v_mul_f32 v33, v33, v34
    v_cvt_pk_bf16_f32 v32, v32, v33
    v_mul_u32_u24 v1, 7168, v2
    v_lshl_add_u32 v1, v22, 3, v1
    s_lshl_b32 s84, s76, 7
    s_add_u32 s84, s84, 2228224
    v_mov_b32 v2, 128
    s_branch K1_nonceloop
K1_qstore:
    v_cvt_pk_bf16_f32 v32, v32, v33
    v_lshlrev_b32 v1, 14, v2
    v_lshl_add_u32 v1, v22, 3, v1
    s_lshl_b32 s84, s76, 7
    s_add_u32 s84, s84, 2097152
    s_waitcnt vmcnt(0)
    v_readfirstlane_b32 s39, v226
    s_cmp_lg_u32 s39, 0
    s_cbranch_scc1 K1_havenonce
    v_mov_b32 v2, 128
K1_nonceloop:
    buffer_load_dword v226, v2, s[72:75], 0 offen sc0 sc1
    s_waitcnt vmcnt(0)
    v_readfirstlane_b32 s39, v226
    s_cmp_eq_u32 s39, 0
    s_cbranch_scc1 K1_nonceloop
K1_havenonce:
    s_nop 0
    v_mov_b32 v33, s39
    buffer_store_dwordx2 v[32:33], v1, s[20:23], s84 offen sc0 sc1
    s_branch K2_poll
K2_getnonce:
    v_mov_b32 v2, 128
K2_nonceloop:
    buffer_load_dword v226, v2, s[72:75], 0 offen sc0 sc1
    s_waitcnt vmcnt(0)
    v_readfirstlane_b32 s39, v226
    s_cmp_lg_u32 s39, 0
    s_cbranch_scc1 K2_poll
    s_sleep 8
    s_branch K2_nonceloop
K2_poll:
    s_lshr_b32 s84, s2, 3
    s_lshl_b32 s84, s84, 11
    s_add_u32 s84, s84, 2097152
    v_lshlrev_b32 v22, 1, v224
    buffer_load_dwordx4 v[64:67], v22, s[20:23], s84 offen sc0 sc1
    buffer_load_dwordx4 v[68:71], v22, s[20:23], s84 offen offset:16 sc0 sc1
    s_sleep 4
    buffer_load_dwordx4 v[72:75], v22, s[20:23], s84 offen sc0 sc1
    buffer_load_dwordx4 v[76:79], v22, s[20:23], s84 offen offset:16 sc0 sc1
    s_sleep 4
    buffer_load_dwordx4 v[80:83], v22, s[20:23], s84 offen sc0 sc1
    buffer_load_dwordx4 v[84:87], v22, s[20:23], s84 offen offset:16 sc0 sc1
    s_sleep 4
K2_pollloop:
    buffer_load_dwordx4 v[88:91], v22, s[20:23], s84 offen sc0 sc1
    buffer_load_dwordx4 v[92:95], v22, s[20:23], s84 offen offset:16 sc0 sc1
    s_waitcnt vmcnt(6)
    v_min_u32 v4, v65, v67
    v_min3_u32 v4, v4, v69, v71
    v_max_u32 v5, v65, v67
    v_max3_u32 v5, v5, v69, v71
    v_cmp_ne_u32 vcc, s39, v4
    v_cmp_ne_u32 s[82:83], s39, v5
    s_or_b64 vcc, vcc, s[82:83]
    s_cbranch_scc0 K2_got0
    s_sleep 4
    buffer_load_dwordx4 v[64:67], v22, s[20:23], s84 offen sc0 sc1
    buffer_load_dwordx4 v[68:71], v22, s[20:23], s84 offen offset:16 sc0 sc1
    s_waitcnt vmcnt(6)
    v_min_u32 v4, v73, v75
    v_min3_u32 v4, v4, v77, v79
    v_max_u32 v5, v73, v75
    v_max3_u32 v5, v5, v77, v79
    v_cmp_ne_u32 vcc, s39, v4
    v_cmp_ne_u32 s[82:83], s39, v5
    s_or_b64 vcc, vcc, s[82:83]
    s_cbranch_scc0 K2_got1
    s_sleep 4
    buffer_load_dwordx4 v[72:75], v22, s[20:23], s84 offen sc0 sc1
    buffer_load_dwordx4 v[76:79], v22, s[20:23], s84 offen offset:16 sc0 sc1
    s_waitcnt vmcnt(6)
    v_min_u32 v4, v81, v83
    v_min3_u32 v4, v4, v85, v87
    v_max_u32 v5, v81, v83
    v_max3_u32 v5, v5, v85, v87
    v_cmp_ne_u32 vcc, s39, v4
    v_cmp_ne_u32 s[82:83], s39, v5
    s_or_b64 vcc, vcc, s[82:83]
    s_cbranch_scc0 K2_got2
    s_sleep 4
    buffer_load_dwordx4 v[80:83], v22, s[20:23], s84 offen sc0 sc1
    buffer_load_dwordx4 v[84:87], v22, s[20:23], s84 offen offset:16 sc0 sc1
    s_waitcnt vmcnt(6)
    v_min_u32 v4, v89, v91
    v_min3_u32 v4, v4, v93, v95
    v_max_u32 v5, v89, v91
    v_max3_u32 v5, v5, v93, v95
    v_cmp_ne_u32 vcc, s39, v4
    v_cmp_ne_u32 s[82:83], s39, v5
    s_or_b64 vcc, vcc, s[82:83]
    s_cbranch_scc0 K2_got3
    s_sleep 4
    s_branch K2_pollloop
K2_got0:
    v_mov_b32 v4, v64
    v_mov_b32 v5, v66
    v_mov_b32 v6, v68
    v_mov_b32 v7, v70
    s_branch K2_gotq
K2_got1:
    v_mov_b32 v4, v72
    v_mov_b32 v5, v74
    v_mov_b32 v6, v76
    v_mov_b32 v7, v78
    s_branch K2_gotq
K2_got2:
    v_mov_b32 v4, v80
    v_mov_b32 v5, v82
    v_mov_b32 v6, v84
    v_mov_b32 v7, v86
    s_branch K2_gotq
K2_got3:
    v_mov_b32 v4, v88
    v_mov_b32 v5, v90
    v_mov_b32 v6, v92
    v_mov_b32 v7, v94
K2_gotq:
    v_mov_b32 v9, 132
K2_rdy:
    buffer_load_dword v8, v9, s[72:75], 0 offen sc0 sc1
    s_waitcnt vmcnt(0)
    v_readfirstlane_b32 s82, v8
    s_cmp_lg_u32 s82, s39
    s_cbranch_scc1 K2_rdy
    ds_write_b128 v225, v[4:7] offset:18432
    v_mov_b32 v8, s39
    v_mov_b32 v9, 19456
    s_waitcnt lgkmcnt(0)
    ds_write_b32 v9, v8
    s_waitcnt vmcnt(0) lgkmcnt(0)
    s_mov_b32 s24, s29
    s_add_u32 s25, s29, 4096
    buffer_load_dwordx4 v[96:99], v224, s[12:15], s24 offen nt
    buffer_load_dwordx4 v[100:103], v224, s[12:15], s24 offen offset:1024 nt
    buffer_load_dwordx4 v[104:107], v224, s[12:15], s24 offen offset:2048 nt
    buffer_load_dwordx4 v[108:111], v224, s[12:15], s24 offen offset:3072 nt
    buffer_load_dwordx4 v[112:115], v224, s[12:15], s25 offen nt
    buffer_load_dwordx4 v[116:119], v224, s[12:15], s25 offen offset:1024 nt
    buffer_load_dwordx4 v[120:123], v224, s[12:15], s25 offen offset:2048 nt
    buffer_load_dwordx4 v[124:127], v224, s[12:15], s25 offen offset:3072 nt
    buffer_load_dwordx4 v[128:131], v225, s[16:19], s24 offen nt
    buffer_load_dwordx4 v[132:135], v225, s[16:19], s24 offen offset:1024 nt
    buffer_load_dwordx4 v[136:139], v225, s[16:19], s24 offen offset:2048 nt
    buffer_load_dwordx4 v[140:143], v225, s[16:19], s24 offen offset:3072 nt
    buffer_load_dwordx4 v[144:147], v225, s[16:19], s25 offen nt
    buffer_load_dwordx4 v[148:151], v225, s[16:19], s25 offen offset:1024 nt
    buffer_load_dwordx4 v[152:155], v225, s[16:19], s25 offen offset:2048 nt
    buffer_load_dwordx4 v[156:159], v225, s[16:19], s25 offen offset:3072 nt
    s_add_u32 s24, s29, 65536
    s_add_u32 s25, s29, 69632
    buffer_load_dwordx4 v[160:163], v224, s[12:15], s24 offen nt
    buffer_load_dwordx4 v[164:167], v224, s[12:15], s24 offen offset:1024 nt
    buffer_load_dwordx4 v[168:171], v224, s[12:15], s24 offen offset:2048 nt
    buffer_load_dwordx4 v[172:175], v224, s[12:15], s24 offen offset:3072 nt
    buffer_load_dwordx4 v[176:179], v224, s[12:15], s25 offen nt
    buffer_load_dwordx4 v[180:183], v224, s[12:15], s25 offen offset:1024 nt
    buffer_load_dwordx4 v[184:187], v224, s[12:15], s25 offen offset:2048 nt
    buffer_load_dwordx4 v[188:191], v224, s[12:15], s25 offen offset:3072 nt
    buffer_load_dwordx4 v[192:195], v225, s[16:19], s24 offen nt
    buffer_load_dwordx4 v[196:199], v225, s[16:19], s24 offen offset:1024 nt
    buffer_load_dwordx4 v[200:203], v225, s[16:19], s24 offen offset:2048 nt
    buffer_load_dwordx4 v[204:207], v225, s[16:19], s24 offen offset:3072 nt
    buffer_load_dwordx4 v[208:211], v225, s[16:19], s25 offen nt
    buffer_load_dwordx4 v[212:215], v225, s[16:19], s25 offen offset:1024 nt
    buffer_load_dwordx4 v[216:219], v225, s[16:19], s25 offen offset:2048 nt
    buffer_load_dwordx4 v[220:223], v225, s[16:19], s25 offen offset:3072 nt
    s_branch K2_qready
K2_qwait:
    v_mov_b32 v9, 19456
K2_flagloop:
    ds_read_b32 v8, v9
    s_waitcnt lgkmcnt(0)
    v_readfirstlane_b32 s39, v8
    s_cmp_lg_u32 s39, 0
    s_cbranch_scc1 K2_qready
    s_sleep 2
    s_branch K2_flagloop
K2_qready:
    ds_read_b128 v[4:7], v225 offset:18432
    v_mov_b32 v9, 19456
    ds_read_b32 v8, v9
    v_mov_b32 v1, v3
    v_mov_b32 v32, 0
    v_mov_b32 v33, 0
    v_mov_b32 v34, 0
    v_mov_b32 v35, 0
    v_mov_b32 v36, 0
    v_mov_b32 v37, 0
    v_mov_b32 v38, 0
    v_mov_b32 v39, 0
    v_mov_b32 v40, 0
    v_mov_b32 v41, 0
    v_mov_b32 v42, 0
    v_mov_b32 v43, 0
    v_mov_b32 v44, 0
    v_mov_b32 v45, 0
    v_mov_b32 v46, 0
    v_mov_b32 v47, 0
    v_mov_b32 v48, 0
    v_mov_b32 v49, 0
    v_mov_b32 v50, 0
    v_mov_b32 v51, 0
    v_mov_b32 v52, 0
    v_mov_b32 v53, 0
    v_mov_b32 v54, 0
    v_mov_b32 v55, 0
    v_mov_b32 v56, 0
    v_mov_b32 v57, 0
    v_mov_b32 v58, 0
    v_mov_b32 v59, 0
    v_mov_b32 v60, 0
    v_mov_b32 v61, 0
    v_mov_b32 v62, 0
    v_mov_b32 v63, 0
    v_mov_b32 v20, 0xf149f2ca
    v_mov_b32 v21, 0
    s_mov_b32 s29, 0
    s_waitcnt lgkmcnt(0)
    v_readfirstlane_b32 s39, v8
    s_load_dwordx2 s[48:49], s[0:1], 32
    s_load_dwordx2 s[50:51], s[0:1], 64
    s_load_dwordx2 s[52:53], s[0:1], 72
    s_load_dwordx2 s[54:55], s[0:1], 80
    s_mov_b32 s29, 0
K2_loop:
    s_add_u32 s24, s24, 65536
    s_add_u32 s25, s25, 65536
    s_waitcnt vmcnt(31)
    v_mfma_f32_16x16x32_bf16 v[64:67], v[96:99], v[4:7], 0
    s_waitcnt vmcnt(30)
    v_mfma_f32_16x16x32_bf16 v[68:71], v[100:103], v[4:7], 0
    s_waitcnt vmcnt(29)
    v_mfma_f32_16x16x32_bf16 v[72:75], v[104:107], v[4:7], 0
    s_waitcnt vmcnt(28)
    v_mfma_f32_16x16x32_bf16 v[76:79], v[108:111], v[4:7], 0
    s_waitcnt vmcnt(27)
    v_mfma_f32_16x16x32_bf16 v[80:83], v[112:115], v[4:7], 0
    s_waitcnt vmcnt(26)
    v_mfma_f32_16x16x32_bf16 v[84:87], v[116:119], v[4:7], 0
    s_waitcnt vmcnt(25)
    v_mfma_f32_16x16x32_bf16 v[88:91], v[120:123], v[4:7], 0
    s_waitcnt vmcnt(24)
    v_mfma_f32_16x16x32_bf16 v[92:95], v[124:127], v[4:7], 0
    buffer_load_dwordx4 v[96:99], v224, s[12:15], s24 offen nt
    buffer_load_dwordx4 v[100:103], v224, s[12:15], s24 offen offset:1024 nt
    buffer_load_dwordx4 v[104:107], v224, s[12:15], s24 offen offset:2048 nt
    buffer_load_dwordx4 v[108:111], v224, s[12:15], s24 offen offset:3072 nt
    buffer_load_dwordx4 v[112:115], v224, s[12:15], s25 offen nt
    buffer_load_dwordx4 v[116:119], v224, s[12:15], s25 offen offset:1024 nt
    buffer_load_dwordx4 v[120:123], v224, s[12:15], s25 offen offset:2048 nt
    buffer_load_dwordx4 v[124:127], v224, s[12:15], s25 offen offset:3072 nt
    v_mov_b32_dpp v8, v64 quad_perm:[0,0,0,0] row_mask:0xf bank_mask:0xf
    v_mov_b32_dpp v9, v68 quad_perm:[0,0,0,0] row_mask:0xf bank_mask:0xf
    v_mov_b32_dpp v10, v72 quad_perm:[0,0,0,0] row_mask:0xf bank_mask:0xf
    v_mov_b32_dpp v11, v76 quad_perm:[0,0,0,0] row_mask:0xf bank_mask:0xf
    v_mov_b32_dpp v12, v80 quad_perm:[0,0,0,0] row_mask:0xf bank_mask:0xf
    v_mov_b32_dpp v13, v84 quad_perm:[0,0,0,0] row_mask:0xf bank_mask:0xf
    v_mov_b32_dpp v14, v88 quad_perm:[0,0,0,0] row_mask:0xf bank_mask:0xf
    v_mov_b32_dpp v15, v92 quad_perm:[0,0,0,0] row_mask:0xf bank_mask:0xf
    v_add_f32_dpp v8, v65, v8 quad_perm:[1,1,1,1] row_mask:0xf bank_mask:0xf
    v_add_f32_dpp v9, v69, v9 quad_perm:[1,1,1,1] row_mask:0xf bank_mask:0xf
    v_add_f32_dpp v10, v73, v10 quad_perm:[1,1,1,1] row_mask:0xf bank_mask:0xf
    v_add_f32_dpp v11, v77, v11 quad_perm:[1,1,1,1] row_mask:0xf bank_mask:0xf
    v_add_f32_dpp v12, v81, v12 quad_perm:[1,1,1,1] row_mask:0xf bank_mask:0xf
    v_add_f32_dpp v13, v85, v13 quad_perm:[1,1,1,1] row_mask:0xf bank_mask:0xf
    v_add_f32_dpp v14, v89, v14 quad_perm:[1,1,1,1] row_mask:0xf bank_mask:0xf
    v_add_f32_dpp v15, v93, v15 quad_perm:[1,1,1,1] row_mask:0xf bank_mask:0xf
    v_add_f32_dpp v8, v66, v8 quad_perm:[2,2,2,2] row_mask:0xf bank_mask:0xf
    v_add_f32_dpp v9, v70, v9 quad_perm:[2,2,2,2] row_mask:0xf bank_mask:0xf
    v_add_f32_dpp v10, v74, v10 quad_perm:[2,2,2,2] row_mask:0xf bank_mask:0xf
    v_add_f32_dpp v11, v78, v11 quad_perm:[2,2,2,2] row_mask:0xf bank_mask:0xf
    v_add_f32_dpp v12, v82, v12 quad_perm:[2,2,2,2] row_mask:0xf bank_mask:0xf
    v_add_f32_dpp v13, v86, v13 quad_perm:[2,2,2,2] row_mask:0xf bank_mask:0xf
    v_add_f32_dpp v14, v90, v14 quad_perm:[2,2,2,2] row_mask:0xf bank_mask:0xf
    v_add_f32_dpp v15, v94, v15 quad_perm:[2,2,2,2] row_mask:0xf bank_mask:0xf
    v_add_f32_dpp v8, v67, v8 quad_perm:[3,3,3,3] row_mask:0xf bank_mask:0xf
    v_add_f32_dpp v9, v71, v9 quad_perm:[3,3,3,3] row_mask:0xf bank_mask:0xf
    v_add_f32_dpp v10, v75, v10 quad_perm:[3,3,3,3] row_mask:0xf bank_mask:0xf
    v_add_f32_dpp v11, v79, v11 quad_perm:[3,3,3,3] row_mask:0xf bank_mask:0xf
    v_add_f32_dpp v12, v83, v12 quad_perm:[3,3,3,3] row_mask:0xf bank_mask:0xf
    v_add_f32_dpp v13, v87, v13 quad_perm:[3,3,3,3] row_mask:0xf bank_mask:0xf
    v_add_f32_dpp v14, v91, v14 quad_perm:[3,3,3,3] row_mask:0xf bank_mask:0xf
    v_add_f32_dpp v15, v95, v15 quad_perm:[3,3,3,3] row_mask:0xf bank_mask:0xf
    v_cvt_pk_bf16_f32 v22, v8, v9
    v_cvt_pk_bf16_f32 v23, v10, v11
    v_cvt_pk_bf16_f32 v24, v12, v13
    v_cvt_pk_bf16_f32 v25, v14, v15
    v_lshlrev_b32 v8, 16, v22
    v_and_b32 v9, 0xffff0000, v22
    v_lshlrev_b32 v10, 16, v23
    v_and_b32 v11, 0xffff0000, v23
    v_lshlrev_b32 v12, 16, v24
    v_and_b32 v13, 0xffff0000, v24
    v_lshlrev_b32 v14, 16, v25
    v_and_b32 v15, 0xffff0000, v25
    v_mul_f32 v8, s38, v8
    v_mul_f32 v9, s38, v9
    v_mul_f32 v10, s38, v10
    v_mul_f32 v11, s38, v11
    v_mul_f32 v12, s38, v12
    v_mul_f32 v13, s38, v13
    v_mul_f32 v14, s38, v14
    v_mul_f32 v15, s38, v15
    v_cvt_pk_bf16_f32 v22, v8, v9
    v_cvt_pk_bf16_f32 v23, v10, v11
    v_cvt_pk_bf16_f32 v24, v12, v13
    v_cvt_pk_bf16_f32 v25, v14, v15
    v_lshlrev_b32 v8, 16, v22
    v_and_b32 v9, 0xffff0000, v22
    v_lshlrev_b32 v10, 16, v23
    v_and_b32 v11, 0xffff0000, v23
    v_lshlrev_b32 v12, 16, v24
    v_and_b32 v13, 0xffff0000, v24
    v_lshlrev_b32 v14, 16, v25
    v_and_b32 v15, 0xffff0000, v25
    v_max3_f32 v22, v8, v9, v10
    v_max3_f32 v22, v22, v11, v12
    v_max3_f32 v22, v22, v13, v14
    v_max_f32 v22, v22, v15
    v_mov_b32 v23, v22
    s_nop 1
    v_permlane16_swap_b32 v22, v23
    s_nop 1
    v_max_f32 v22, v22, v23
    v_mov_b32 v23, v22
    s_nop 1
    v_permlane32_swap_b32 v22, v23
    s_nop 1
    v_max_f32 v22, v22, v23
    v_mul_f32 v22, s28, v22
    v_max_f32 v22, v22, v20
    v_sub_f32 v23, v20, v22
    v_exp_f32 v23, v23
    v_mov_b32 v20, v22
    v_fma_f32 v8, v8, s28, -v22
    v_fma_f32 v9, v9, s28, -v22
    v_fma_f32 v10, v10, s28, -v22
    v_fma_f32 v11, v11, s28, -v22
    v_fma_f32 v12, v12, s28, -v22
    v_fma_f32 v13, v13, s28, -v22
    v_fma_f32 v14, v14, s28, -v22
    v_fma_f32 v15, v15, s28, -v22
    v_exp_f32 v8, v8
    v_exp_f32 v9, v9
    v_exp_f32 v10, v10
    v_exp_f32 v11, v11
    v_exp_f32 v12, v12
    v_exp_f32 v13, v13
    v_exp_f32 v14, v14
    v_exp_f32 v15, v15
    v_mul_f32 v21, v21, v23
    v_add_f32 v21, v21, v8
    v_add_f32 v21, v21, v9
    v_add_f32 v21, v21, v10
    v_add_f32 v21, v21, v11
    v_add_f32 v21, v21, v12
    v_add_f32 v21, v21, v13
    v_add_f32 v21, v21, v14
    v_add_f32 v21, v21, v15
    v_cvt_pk_bf16_f32 v16, v8, v9
    v_cvt_pk_bf16_f32 v17, v10, v11
    v_cvt_pk_bf16_f32 v18, v12, v13
    v_cvt_pk_bf16_f32 v19, v14, v15
    v_mul_f32 v32, v32, v23
    v_mul_f32 v33, v33, v23
    v_mul_f32 v34, v34, v23
    v_mul_f32 v35, v35, v23
    v_mul_f32 v36, v36, v23
    v_mul_f32 v37, v37, v23
    v_mul_f32 v38, v38, v23
    v_mul_f32 v39, v39, v23
    v_mul_f32 v40, v40, v23
    v_mul_f32 v41, v41, v23
    v_mul_f32 v42, v42, v23
    v_mul_f32 v43, v43, v23
    v_mul_f32 v44, v44, v23
    v_mul_f32 v45, v45, v23
    v_mul_f32 v46, v46, v23
    v_mul_f32 v47, v47, v23
    v_mul_f32 v48, v48, v23
    v_mul_f32 v49, v49, v23
    v_mul_f32 v50, v50, v23
    v_mul_f32 v51, v51, v23
    v_mul_f32 v52, v52, v23
    v_mul_f32 v53, v53, v23
    v_mul_f32 v54, v54, v23
    v_mul_f32 v55, v55, v23
    v_mul_f32 v56, v56, v23
    v_mul_f32 v57, v57, v23
    v_mul_f32 v58, v58, v23
    v_mul_f32 v59, v59, v23
    v_mul_f32 v60, v60, v23
    v_mul_f32 v61, v61, v23
    v_mul_f32 v62, v62, v23
    v_mul_f32 v63, v63, v23
    s_waitcnt vmcnt(24)
    v_perm_b32 v64, v132, v128, s26
    v_perm_b32 v65, v140, v136, s26
    v_perm_b32 v66, v148, v144, s26
    v_perm_b32 v67, v156, v152, s26
    v_perm_b32 v68, v132, v128, s27
    v_perm_b32 v69, v140, v136, s27
    v_perm_b32 v70, v148, v144, s27
    v_perm_b32 v71, v156, v152, s27
    v_perm_b32 v72, v133, v129, s26
    v_perm_b32 v73, v141, v137, s26
    v_perm_b32 v74, v149, v145, s26
    v_perm_b32 v75, v157, v153, s26
    v_perm_b32 v76, v133, v129, s27
    v_perm_b32 v77, v141, v137, s27
    v_perm_b32 v78, v149, v145, s27
    v_perm_b32 v79, v157, v153, s27
    v_perm_b32 v80, v134, v130, s26
    v_perm_b32 v81, v142, v138, s26
    v_perm_b32 v82, v150, v146, s26
    v_perm_b32 v83, v158, v154, s26
    v_perm_b32 v84, v134, v130, s27
    v_perm_b32 v85, v142, v138, s27
    v_perm_b32 v86, v150, v146, s27
    v_perm_b32 v87, v158, v154, s27
    v_perm_b32 v88, v135, v131, s26
    v_perm_b32 v89, v143, v139, s26
    v_perm_b32 v90, v151, v147, s26
    v_perm_b32 v91, v159, v155, s26
    v_perm_b32 v92, v135, v131, s27
    v_perm_b32 v93, v143, v139, s27
    v_perm_b32 v94, v151, v147, s27
    v_perm_b32 v95, v159, v155, s27
    buffer_load_dwordx4 v[128:131], v225, s[16:19], s24 offen nt
    buffer_load_dwordx4 v[132:135], v225, s[16:19], s24 offen offset:1024 nt
    buffer_load_dwordx4 v[136:139], v225, s[16:19], s24 offen offset:2048 nt
    buffer_load_dwordx4 v[140:143], v225, s[16:19], s24 offen offset:3072 nt
    buffer_load_dwordx4 v[144:147], v225, s[16:19], s25 offen nt
    buffer_load_dwordx4 v[148:151], v225, s[16:19], s25 offen offset:1024 nt
    buffer_load_dwordx4 v[152:155], v225, s[16:19], s25 offen offset:2048 nt
    buffer_load_dwordx4 v[156:159], v225, s[16:19], s25 offen offset:3072 nt
    v_mfma_f32_16x16x32_bf16 v[32:35], v[64:67], v[16:19], v[32:35]
    v_mfma_f32_16x16x32_bf16 v[36:39], v[68:71], v[16:19], v[36:39]
    v_mfma_f32_16x16x32_bf16 v[40:43], v[72:75], v[16:19], v[40:43]
    v_mfma_f32_16x16x32_bf16 v[44:47], v[76:79], v[16:19], v[44:47]
    v_mfma_f32_16x16x32_bf16 v[48:51], v[80:83], v[16:19], v[48:51]
    v_mfma_f32_16x16x32_bf16 v[52:55], v[84:87], v[16:19], v[52:55]
    v_mfma_f32_16x16x32_bf16 v[56:59], v[88:91], v[16:19], v[56:59]
    v_mfma_f32_16x16x32_bf16 v[60:63], v[92:95], v[16:19], v[60:63]
    s_add_u32 s24, s24, 65536
    s_add_u32 s25, s25, 65536
    s_waitcnt vmcnt(31)
    v_mfma_f32_16x16x32_bf16 v[64:67], v[160:163], v[4:7], 0
    s_waitcnt vmcnt(30)
    v_mfma_f32_16x16x32_bf16 v[68:71], v[164:167], v[4:7], 0
    s_waitcnt vmcnt(29)
    v_mfma_f32_16x16x32_bf16 v[72:75], v[168:171], v[4:7], 0
    s_waitcnt vmcnt(28)
    v_mfma_f32_16x16x32_bf16 v[76:79], v[172:175], v[4:7], 0
    s_waitcnt vmcnt(27)
    v_mfma_f32_16x16x32_bf16 v[80:83], v[176:179], v[4:7], 0
    s_waitcnt vmcnt(26)
    v_mfma_f32_16x16x32_bf16 v[84:87], v[180:183], v[4:7], 0
    s_waitcnt vmcnt(25)
    v_mfma_f32_16x16x32_bf16 v[88:91], v[184:187], v[4:7], 0
    s_waitcnt vmcnt(24)
    v_mfma_f32_16x16x32_bf16 v[92:95], v[188:191], v[4:7], 0
    buffer_load_dwordx4 v[160:163], v224, s[12:15], s24 offen nt
    buffer_load_dwordx4 v[164:167], v224, s[12:15], s24 offen offset:1024 nt
    buffer_load_dwordx4 v[168:171], v224, s[12:15], s24 offen offset:2048 nt
    buffer_load_dwordx4 v[172:175], v224, s[12:15], s24 offen offset:3072 nt
    buffer_load_dwordx4 v[176:179], v224, s[12:15], s25 offen nt
    buffer_load_dwordx4 v[180:183], v224, s[12:15], s25 offen offset:1024 nt
    buffer_load_dwordx4 v[184:187], v224, s[12:15], s25 offen offset:2048 nt
    buffer_load_dwordx4 v[188:191], v224, s[12:15], s25 offen offset:3072 nt
    v_mov_b32_dpp v8, v64 quad_perm:[0,0,0,0] row_mask:0xf bank_mask:0xf
    v_mov_b32_dpp v9, v68 quad_perm:[0,0,0,0] row_mask:0xf bank_mask:0xf
    v_mov_b32_dpp v10, v72 quad_perm:[0,0,0,0] row_mask:0xf bank_mask:0xf
    v_mov_b32_dpp v11, v76 quad_perm:[0,0,0,0] row_mask:0xf bank_mask:0xf
    v_mov_b32_dpp v12, v80 quad_perm:[0,0,0,0] row_mask:0xf bank_mask:0xf
    v_mov_b32_dpp v13, v84 quad_perm:[0,0,0,0] row_mask:0xf bank_mask:0xf
    v_mov_b32_dpp v14, v88 quad_perm:[0,0,0,0] row_mask:0xf bank_mask:0xf
    v_mov_b32_dpp v15, v92 quad_perm:[0,0,0,0] row_mask:0xf bank_mask:0xf
    v_add_f32_dpp v8, v65, v8 quad_perm:[1,1,1,1] row_mask:0xf bank_mask:0xf
    v_add_f32_dpp v9, v69, v9 quad_perm:[1,1,1,1] row_mask:0xf bank_mask:0xf
    v_add_f32_dpp v10, v73, v10 quad_perm:[1,1,1,1] row_mask:0xf bank_mask:0xf
    v_add_f32_dpp v11, v77, v11 quad_perm:[1,1,1,1] row_mask:0xf bank_mask:0xf
    v_add_f32_dpp v12, v81, v12 quad_perm:[1,1,1,1] row_mask:0xf bank_mask:0xf
    v_add_f32_dpp v13, v85, v13 quad_perm:[1,1,1,1] row_mask:0xf bank_mask:0xf
    v_add_f32_dpp v14, v89, v14 quad_perm:[1,1,1,1] row_mask:0xf bank_mask:0xf
    v_add_f32_dpp v15, v93, v15 quad_perm:[1,1,1,1] row_mask:0xf bank_mask:0xf
    v_add_f32_dpp v8, v66, v8 quad_perm:[2,2,2,2] row_mask:0xf bank_mask:0xf
    v_add_f32_dpp v9, v70, v9 quad_perm:[2,2,2,2] row_mask:0xf bank_mask:0xf
    v_add_f32_dpp v10, v74, v10 quad_perm:[2,2,2,2] row_mask:0xf bank_mask:0xf
    v_add_f32_dpp v11, v78, v11 quad_perm:[2,2,2,2] row_mask:0xf bank_mask:0xf
    v_add_f32_dpp v12, v82, v12 quad_perm:[2,2,2,2] row_mask:0xf bank_mask:0xf
    v_add_f32_dpp v13, v86, v13 quad_perm:[2,2,2,2] row_mask:0xf bank_mask:0xf
    v_add_f32_dpp v14, v90, v14 quad_perm:[2,2,2,2] row_mask:0xf bank_mask:0xf
    v_add_f32_dpp v15, v94, v15 quad_perm:[2,2,2,2] row_mask:0xf bank_mask:0xf
    v_add_f32_dpp v8, v67, v8 quad_perm:[3,3,3,3] row_mask:0xf bank_mask:0xf
    v_add_f32_dpp v9, v71, v9 quad_perm:[3,3,3,3] row_mask:0xf bank_mask:0xf
    v_add_f32_dpp v10, v75, v10 quad_perm:[3,3,3,3] row_mask:0xf bank_mask:0xf
    v_add_f32_dpp v11, v79, v11 quad_perm:[3,3,3,3] row_mask:0xf bank_mask:0xf
    v_add_f32_dpp v12, v83, v12 quad_perm:[3,3,3,3] row_mask:0xf bank_mask:0xf
    v_add_f32_dpp v13, v87, v13 quad_perm:[3,3,3,3] row_mask:0xf bank_mask:0xf
    v_add_f32_dpp v14, v91, v14 quad_perm:[3,3,3,3] row_mask:0xf bank_mask:0xf
    v_add_f32_dpp v15, v95, v15 quad_perm:[3,3,3,3] row_mask:0xf bank_mask:0xf
    v_cvt_pk_bf16_f32 v22, v8, v9
    v_cvt_pk_bf16_f32 v23, v10, v11
    v_cvt_pk_bf16_f32 v24, v12, v13
    v_cvt_pk_bf16_f32 v25, v14, v15
    v_lshlrev_b32 v8, 16, v22
    v_and_b32 v9, 0xffff0000, v22
    v_lshlrev_b32 v10, 16, v23
    v_and_b32 v11, 0xffff0000, v23
    v_lshlrev_b32 v12, 16, v24
    v_and_b32 v13, 0xffff0000, v24
    v_lshlrev_b32 v14, 16, v25
    v_and_b32 v15, 0xffff0000, v25
    v_mul_f32 v8, s38, v8
    v_mul_f32 v9, s38, v9
    v_mul_f32 v10, s38, v10
    v_mul_f32 v11, s38, v11
    v_mul_f32 v12, s38, v12
    v_mul_f32 v13, s38, v13
    v_mul_f32 v14, s38, v14
    v_mul_f32 v15, s38, v15
    v_cvt_pk_bf16_f32 v22, v8, v9
    v_cvt_pk_bf16_f32 v23, v10, v11
    v_cvt_pk_bf16_f32 v24, v12, v13
    v_cvt_pk_bf16_f32 v25, v14, v15
    v_lshlrev_b32 v8, 16, v22
    v_and_b32 v9, 0xffff0000, v22
    v_lshlrev_b32 v10, 16, v23
    v_and_b32 v11, 0xffff0000, v23
    v_lshlrev_b32 v12, 16, v24
    v_and_b32 v13, 0xffff0000, v24
    v_lshlrev_b32 v14, 16, v25
    v_and_b32 v15, 0xffff0000, v25
    v_max3_f32 v22, v8, v9, v10
    v_max3_f32 v22, v22, v11, v12
    v_max3_f32 v22, v22, v13, v14
    v_max_f32 v22, v22, v15
    v_mov_b32 v23, v22
    s_nop 1
    v_permlane16_swap_b32 v22, v23
    s_nop 1
    v_max_f32 v22, v22, v23
    v_mov_b32 v23, v22
    s_nop 1
    v_permlane32_swap_b32 v22, v23
    s_nop 1
    v_max_f32 v22, v22, v23
    v_mul_f32 v22, s28, v22
    v_max_f32 v22, v22, v20
    v_sub_f32 v23, v20, v22
    v_exp_f32 v23, v23
    v_mov_b32 v20, v22
    v_fma_f32 v8, v8, s28, -v22
    v_fma_f32 v9, v9, s28, -v22
    v_fma_f32 v10, v10, s28, -v22
    v_fma_f32 v11, v11, s28, -v22
    v_fma_f32 v12, v12, s28, -v22
    v_fma_f32 v13, v13, s28, -v22
    v_fma_f32 v14, v14, s28, -v22
    v_fma_f32 v15, v15, s28, -v22
    v_exp_f32 v8, v8
    v_exp_f32 v9, v9
    v_exp_f32 v10, v10
    v_exp_f32 v11, v11
    v_exp_f32 v12, v12
    v_exp_f32 v13, v13
    v_exp_f32 v14, v14
    v_exp_f32 v15, v15
    v_mul_f32 v21, v21, v23
    v_add_f32 v21, v21, v8
    v_add_f32 v21, v21, v9
    v_add_f32 v21, v21, v10
    v_add_f32 v21, v21, v11
    v_add_f32 v21, v21, v12
    v_add_f32 v21, v21, v13
    v_add_f32 v21, v21, v14
    v_add_f32 v21, v21, v15
    v_cvt_pk_bf16_f32 v16, v8, v9
    v_cvt_pk_bf16_f32 v17, v10, v11
    v_cvt_pk_bf16_f32 v18, v12, v13
    v_cvt_pk_bf16_f32 v19, v14, v15
    v_mul_f32 v32, v32, v23
    v_mul_f32 v33, v33, v23
    v_mul_f32 v34, v34, v23
    v_mul_f32 v35, v35, v23
    v_mul_f32 v36, v36, v23
    v_mul_f32 v37, v37, v23
    v_mul_f32 v38, v38, v23
    v_mul_f32 v39, v39, v23
    v_mul_f32 v40, v40, v23
    v_mul_f32 v41, v41, v23
    v_mul_f32 v42, v42, v23
    v_mul_f32 v43, v43, v23
    v_mul_f32 v44, v44, v23
    v_mul_f32 v45, v45, v23
    v_mul_f32 v46, v46, v23
    v_mul_f32 v47, v47, v23
    v_mul_f32 v48, v48, v23
    v_mul_f32 v49, v49, v23
    v_mul_f32 v50, v50, v23
    v_mul_f32 v51, v51, v23
    v_mul_f32 v52, v52, v23
    v_mul_f32 v53, v53, v23
    v_mul_f32 v54, v54, v23
    v_mul_f32 v55, v55, v23
    v_mul_f32 v56, v56, v23
    v_mul_f32 v57, v57, v23
    v_mul_f32 v58, v58, v23
    v_mul_f32 v59, v59, v23
    v_mul_f32 v60, v60, v23
    v_mul_f32 v61, v61, v23
    v_mul_f32 v62, v62, v23
    v_mul_f32 v63, v63, v23
    s_waitcnt vmcnt(24)
    v_perm_b32 v64, v196, v192, s26
    v_perm_b32 v65, v204, v200, s26
    v_perm_b32 v66, v212, v208, s26
    v_perm_b32 v67, v220, v216, s26
    v_perm_b32 v68, v196, v192, s27
    v_perm_b32 v69, v204, v200, s27
    v_perm_b32 v70, v212, v208, s27
    v_perm_b32 v71, v220, v216, s27
    v_perm_b32 v72, v197, v193, s26
    v_perm_b32 v73, v205, v201, s26
    v_perm_b32 v74, v213, v209, s26
    v_perm_b32 v75, v221, v217, s26
    v_perm_b32 v76, v197, v193, s27
    v_perm_b32 v77, v205, v201, s27
    v_perm_b32 v78, v213, v209, s27
    v_perm_b32 v79, v221, v217, s27
    v_perm_b32 v80, v198, v194, s26
    v_perm_b32 v81, v206, v202, s26
    v_perm_b32 v82, v214, v210, s26
    v_perm_b32 v83, v222, v218, s26
    v_perm_b32 v84, v198, v194, s27
    v_perm_b32 v85, v206, v202, s27
    v_perm_b32 v86, v214, v210, s27
    v_perm_b32 v87, v222, v218, s27
    v_perm_b32 v88, v199, v195, s26
    v_perm_b32 v89, v207, v203, s26
    v_perm_b32 v90, v215, v211, s26
    v_perm_b32 v91, v223, v219, s26
    v_perm_b32 v92, v199, v195, s27
    v_perm_b32 v93, v207, v203, s27
    v_perm_b32 v94, v215, v211, s27
    v_perm_b32 v95, v223, v219, s27
    buffer_load_dwordx4 v[192:195], v225, s[16:19], s24 offen nt
    buffer_load_dwordx4 v[196:199], v225, s[16:19], s24 offen offset:1024 nt
    buffer_load_dwordx4 v[200:203], v225, s[16:19], s24 offen offset:2048 nt
    buffer_load_dwordx4 v[204:207], v225, s[16:19], s24 offen offset:3072 nt
    buffer_load_dwordx4 v[208:211], v225, s[16:19], s25 offen nt
    buffer_load_dwordx4 v[212:215], v225, s[16:19], s25 offen offset:1024 nt
    buffer_load_dwordx4 v[216:219], v225, s[16:19], s25 offen offset:2048 nt
    buffer_load_dwordx4 v[220:223], v225, s[16:19], s25 offen offset:3072 nt
    v_mfma_f32_16x16x32_bf16 v[32:35], v[64:67], v[16:19], v[32:35]
    v_mfma_f32_16x16x32_bf16 v[36:39], v[68:71], v[16:19], v[36:39]
    v_mfma_f32_16x16x32_bf16 v[40:43], v[72:75], v[16:19], v[40:43]
    v_mfma_f32_16x16x32_bf16 v[44:47], v[76:79], v[16:19], v[44:47]
    v_mfma_f32_16x16x32_bf16 v[48:51], v[80:83], v[16:19], v[48:51]
    v_mfma_f32_16x16x32_bf16 v[52:55], v[84:87], v[16:19], v[52:55]
    v_mfma_f32_16x16x32_bf16 v[56:59], v[88:91], v[16:19], v[56:59]
    v_mfma_f32_16x16x32_bf16 v[60:63], v[92:95], v[16:19], v[60:63]
    s_add_u32 s29, s29, 1
    s_cmp_lt_u32 s29, 2
    s_cbranch_scc1 K2_loop
    s_waitcnt vmcnt(31)
    v_mfma_f32_16x16x32_bf16 v[64:67], v[96:99], v[4:7], 0
    s_waitcnt vmcnt(30)
    v_mfma_f32_16x16x32_bf16 v[68:71], v[100:103], v[4:7], 0
    s_waitcnt vmcnt(29)
    v_mfma_f32_16x16x32_bf16 v[72:75], v[104:107], v[4:7], 0
    s_waitcnt vmcnt(28)
    v_mfma_f32_16x16x32_bf16 v[76:79], v[108:111], v[4:7], 0
    s_waitcnt vmcnt(27)
    v_mfma_f32_16x16x32_bf16 v[80:83], v[112:115], v[4:7], 0
    s_waitcnt vmcnt(26)
    v_mfma_f32_16x16x32_bf16 v[84:87], v[116:119], v[4:7], 0
    s_waitcnt vmcnt(25)
    v_mfma_f32_16x16x32_bf16 v[88:91], v[120:123], v[4:7], 0
    s_waitcnt vmcnt(24)
    v_mfma_f32_16x16x32_bf16 v[92:95], v[124:127], v[4:7], 0
    s_nop 7
    v_mov_b32_dpp v8, v64 quad_perm:[0,0,0,0] row_mask:0xf bank_mask:0xf
    v_mov_b32_dpp v9, v68 quad_perm:[0,0,0,0] row_mask:0xf bank_mask:0xf
    v_mov_b32_dpp v10, v72 quad_perm:[0,0,0,0] row_mask:0xf bank_mask:0xf
    v_mov_b32_dpp v11, v76 quad_perm:[0,0,0,0] row_mask:0xf bank_mask:0xf
    v_mov_b32_dpp v12, v80 quad_perm:[0,0,0,0] row_mask:0xf bank_mask:0xf
    v_mov_b32_dpp v13, v84 quad_perm:[0,0,0,0] row_mask:0xf bank_mask:0xf
    v_mov_b32_dpp v14, v88 quad_perm:[0,0,0,0] row_mask:0xf bank_mask:0xf
    v_mov_b32_dpp v15, v92 quad_perm:[0,0,0,0] row_mask:0xf bank_mask:0xf
    v_add_f32_dpp v8, v65, v8 quad_perm:[1,1,1,1] row_mask:0xf bank_mask:0xf
    v_add_f32_dpp v9, v69, v9 quad_perm:[1,1,1,1] row_mask:0xf bank_mask:0xf
    v_add_f32_dpp v10, v73, v10 quad_perm:[1,1,1,1] row_mask:0xf bank_mask:0xf
    v_add_f32_dpp v11, v77, v11 quad_perm:[1,1,1,1] row_mask:0xf bank_mask:0xf
    v_add_f32_dpp v12, v81, v12 quad_perm:[1,1,1,1] row_mask:0xf bank_mask:0xf
    v_add_f32_dpp v13, v85, v13 quad_perm:[1,1,1,1] row_mask:0xf bank_mask:0xf
    v_add_f32_dpp v14, v89, v14 quad_perm:[1,1,1,1] row_mask:0xf bank_mask:0xf
    v_add_f32_dpp v15, v93, v15 quad_perm:[1,1,1,1] row_mask:0xf bank_mask:0xf
    v_add_f32_dpp v8, v66, v8 quad_perm:[2,2,2,2] row_mask:0xf bank_mask:0xf
    v_add_f32_dpp v9, v70, v9 quad_perm:[2,2,2,2] row_mask:0xf bank_mask:0xf
    v_add_f32_dpp v10, v74, v10 quad_perm:[2,2,2,2] row_mask:0xf bank_mask:0xf
    v_add_f32_dpp v11, v78, v11 quad_perm:[2,2,2,2] row_mask:0xf bank_mask:0xf
    v_add_f32_dpp v12, v82, v12 quad_perm:[2,2,2,2] row_mask:0xf bank_mask:0xf
    v_add_f32_dpp v13, v86, v13 quad_perm:[2,2,2,2] row_mask:0xf bank_mask:0xf
    v_add_f32_dpp v14, v90, v14 quad_perm:[2,2,2,2] row_mask:0xf bank_mask:0xf
    v_add_f32_dpp v15, v94, v15 quad_perm:[2,2,2,2] row_mask:0xf bank_mask:0xf
    v_add_f32_dpp v8, v67, v8 quad_perm:[3,3,3,3] row_mask:0xf bank_mask:0xf
    v_add_f32_dpp v9, v71, v9 quad_perm:[3,3,3,3] row_mask:0xf bank_mask:0xf
    v_add_f32_dpp v10, v75, v10 quad_perm:[3,3,3,3] row_mask:0xf bank_mask:0xf
    v_add_f32_dpp v11, v79, v11 quad_perm:[3,3,3,3] row_mask:0xf bank_mask:0xf
    v_add_f32_dpp v12, v83, v12 quad_perm:[3,3,3,3] row_mask:0xf bank_mask:0xf
    v_add_f32_dpp v13, v87, v13 quad_perm:[3,3,3,3] row_mask:0xf bank_mask:0xf
    v_add_f32_dpp v14, v91, v14 quad_perm:[3,3,3,3] row_mask:0xf bank_mask:0xf
    v_add_f32_dpp v15, v95, v15 quad_perm:[3,3,3,3] row_mask:0xf bank_mask:0xf
    v_cvt_pk_bf16_f32 v22, v8, v9
    v_cvt_pk_bf16_f32 v23, v10, v11
    v_cvt_pk_bf16_f32 v24, v12, v13
    v_cvt_pk_bf16_f32 v25, v14, v15
    v_lshlrev_b32 v8, 16, v22
    v_and_b32 v9, 0xffff0000, v22
    v_lshlrev_b32 v10, 16, v23
    v_and_b32 v11, 0xffff0000, v23
    v_lshlrev_b32 v12, 16, v24
    v_and_b32 v13, 0xffff0000, v24
    v_lshlrev_b32 v14, 16, v25
    v_and_b32 v15, 0xffff0000, v25
    v_mul_f32 v8, s38, v8
    v_mul_f32 v9, s38, v9
    v_mul_f32 v10, s38, v10
    v_mul_f32 v11, s38, v11
    v_mul_f32 v12, s38, v12
    v_mul_f32 v13, s38, v13
    v_mul_f32 v14, s38, v14
    v_mul_f32 v15, s38, v15
    v_cvt_pk_bf16_f32 v22, v8, v9
    v_cvt_pk_bf16_f32 v23, v10, v11
    v_cvt_pk_bf16_f32 v24, v12, v13
    v_cvt_pk_bf16_f32 v25, v14, v15
    v_lshlrev_b32 v8, 16, v22
    v_and_b32 v9, 0xffff0000, v22
    v_lshlrev_b32 v10, 16, v23
    v_and_b32 v11, 0xffff0000, v23
    v_lshlrev_b32 v12, 16, v24
    v_and_b32 v13, 0xffff0000, v24
    v_lshlrev_b32 v14, 16, v25
    v_and_b32 v15, 0xffff0000, v25
    v_max3_f32 v22, v8, v9, v10
    v_max3_f32 v22, v22, v11, v12
    v_max3_f32 v22, v22, v13, v14
    v_max_f32 v22, v22, v15
    v_mov_b32 v23, v22
    s_nop 1
    v_permlane16_swap_b32 v22, v23
    s_nop 1
    v_max_f32 v22, v22, v23
    v_mov_b32 v23, v22
    s_nop 1
    v_permlane32_swap_b32 v22, v23
    s_nop 1
    v_max_f32 v22, v22, v23
    v_mul_f32 v22, s28, v22
    v_max_f32 v22, v22, v20
    v_sub_f32 v23, v20, v22
    v_exp_f32 v23, v23
    v_mov_b32 v20, v22
    v_fma_f32 v8, v8, s28, -v22
    v_fma_f32 v9, v9, s28, -v22
    v_fma_f32 v10, v10, s28, -v22
    v_fma_f32 v11, v11, s28, -v22
    v_fma_f32 v12, v12, s28, -v22
    v_fma_f32 v13, v13, s28, -v22
    v_fma_f32 v14, v14, s28, -v22
    v_fma_f32 v15, v15, s28, -v22
    v_exp_f32 v8, v8
    v_exp_f32 v9, v9
    v_exp_f32 v10, v10
    v_exp_f32 v11, v11
    v_exp_f32 v12, v12
    v_exp_f32 v13, v13
    v_exp_f32 v14, v14
    v_exp_f32 v15, v15
    v_mul_f32 v21, v21, v23
    v_add_f32 v21, v21, v8
    v_add_f32 v21, v21, v9
    v_add_f32 v21, v21, v10
    v_add_f32 v21, v21, v11
    v_add_f32 v21, v21, v12
    v_add_f32 v21, v21, v13
    v_add_f32 v21, v21, v14
    v_add_f32 v21, v21, v15
    v_cvt_pk_bf16_f32 v16, v8, v9
    v_cvt_pk_bf16_f32 v17, v10, v11
    v_cvt_pk_bf16_f32 v18, v12, v13
    v_cvt_pk_bf16_f32 v19, v14, v15
    v_mul_f32 v32, v32, v23
    v_mul_f32 v33, v33, v23
    v_mul_f32 v34, v34, v23
    v_mul_f32 v35, v35, v23
    v_mul_f32 v36, v36, v23
    v_mul_f32 v37, v37, v23
    v_mul_f32 v38, v38, v23
    v_mul_f32 v39, v39, v23
    v_mul_f32 v40, v40, v23
    v_mul_f32 v41, v41, v23
    v_mul_f32 v42, v42, v23
    v_mul_f32 v43, v43, v23
    v_mul_f32 v44, v44, v23
    v_mul_f32 v45, v45, v23
    v_mul_f32 v46, v46, v23
    v_mul_f32 v47, v47, v23
    v_mul_f32 v48, v48, v23
    v_mul_f32 v49, v49, v23
    v_mul_f32 v50, v50, v23
    v_mul_f32 v51, v51, v23
    v_mul_f32 v52, v52, v23
    v_mul_f32 v53, v53, v23
    v_mul_f32 v54, v54, v23
    v_mul_f32 v55, v55, v23
    v_mul_f32 v56, v56, v23
    v_mul_f32 v57, v57, v23
    v_mul_f32 v58, v58, v23
    v_mul_f32 v59, v59, v23
    v_mul_f32 v60, v60, v23
    v_mul_f32 v61, v61, v23
    v_mul_f32 v62, v62, v23
    v_mul_f32 v63, v63, v23
    s_waitcnt vmcnt(16)
    v_perm_b32 v64, v132, v128, s26
    v_perm_b32 v65, v140, v136, s26
    v_perm_b32 v66, v148, v144, s26
    v_perm_b32 v67, v156, v152, s26
    v_perm_b32 v68, v132, v128, s27
    v_perm_b32 v69, v140, v136, s27
    v_perm_b32 v70, v148, v144, s27
    v_perm_b32 v71, v156, v152, s27
    v_perm_b32 v72, v133, v129, s26
    v_perm_b32 v73, v141, v137, s26
    v_perm_b32 v74, v149, v145, s26
    v_perm_b32 v75, v157, v153, s26
    v_perm_b32 v76, v133, v129, s27
    v_perm_b32 v77, v141, v137, s27
    v_perm_b32 v78, v149, v145, s27
    v_perm_b32 v79, v157, v153, s27
    v_perm_b32 v80, v134, v130, s26
    v_perm_b32 v81, v142, v138, s26
    v_perm_b32 v82, v150, v146, s26
    v_perm_b32 v83, v158, v154, s26
    v_perm_b32 v84, v134, v130, s27
    v_perm_b32 v85, v142, v138, s27
    v_perm_b32 v86, v150, v146, s27
    v_perm_b32 v87, v158, v154, s27
    v_perm_b32 v88, v135, v131, s26
    v_perm_b32 v89, v143, v139, s26
    v_perm_b32 v90, v151, v147, s26
    v_perm_b32 v91, v159, v155, s26
    v_perm_b32 v92, v135, v131, s27
    v_perm_b32 v93, v143, v139, s27
    v_perm_b32 v94, v151, v147, s27
    v_perm_b32 v95, v159, v155, s27
    s_nop 1
    v_mfma_f32_16x16x32_bf16 v[32:35], v[64:67], v[16:19], v[32:35]
    v_mfma_f32_16x16x32_bf16 v[36:39], v[68:71], v[16:19], v[36:39]
    v_mfma_f32_16x16x32_bf16 v[40:43], v[72:75], v[16:19], v[40:43]
    v_mfma_f32_16x16x32_bf16 v[44:47], v[76:79], v[16:19], v[44:47]
    v_mfma_f32_16x16x32_bf16 v[48:51], v[80:83], v[16:19], v[48:51]
    v_mfma_f32_16x16x32_bf16 v[52:55], v[84:87], v[16:19], v[52:55]
    v_mfma_f32_16x16x32_bf16 v[56:59], v[88:91], v[16:19], v[56:59]
    v_mfma_f32_16x16x32_bf16 v[60:63], v[92:95], v[16:19], v[60:63]
    v_mov_b32 v8, 1
    v_mov_b32 v9, 19460
    s_mov_b64 exec, 1
    ds_add_u32 v9, v8
    s_mov_b64 exec, -1
    s_waitcnt vmcnt(15)
    v_mfma_f32_16x16x32_bf16 v[64:67], v[160:163], v[4:7], 0
    s_waitcnt vmcnt(14)
    v_mfma_f32_16x16x32_bf16 v[68:71], v[164:167], v[4:7], 0
    s_waitcnt vmcnt(13)
    v_mfma_f32_16x16x32_bf16 v[72:75], v[168:171], v[4:7], 0
    s_waitcnt vmcnt(12)
    v_mfma_f32_16x16x32_bf16 v[76:79], v[172:175], v[4:7], 0
    s_waitcnt vmcnt(11)
    v_mfma_f32_16x16x32_bf16 v[80:83], v[176:179], v[4:7], 0
    s_waitcnt vmcnt(10)
    v_mfma_f32_16x16x32_bf16 v[84:87], v[180:183], v[4:7], 0
    s_waitcnt vmcnt(9)
    v_mfma_f32_16x16x32_bf16 v[88:91], v[184:187], v[4:7], 0
    s_waitcnt vmcnt(8)
    v_mfma_f32_16x16x32_bf16 v[92:95], v[188:191], v[4:7], 0
    s_nop 7
    v_mov_b32_dpp v8, v64 quad_perm:[0,0,0,0] row_mask:0xf bank_mask:0xf
    v_mov_b32_dpp v9, v68 quad_perm:[0,0,0,0] row_mask:0xf bank_mask:0xf
    v_mov_b32_dpp v10, v72 quad_perm:[0,0,0,0] row_mask:0xf bank_mask:0xf
    v_mov_b32_dpp v11, v76 quad_perm:[0,0,0,0] row_mask:0xf bank_mask:0xf
    v_mov_b32_dpp v12, v80 quad_perm:[0,0,0,0] row_mask:0xf bank_mask:0xf
    v_mov_b32_dpp v13, v84 quad_perm:[0,0,0,0] row_mask:0xf bank_mask:0xf
    v_mov_b32_dpp v14, v88 quad_perm:[0,0,0,0] row_mask:0xf bank_mask:0xf
    v_mov_b32_dpp v15, v92 quad_perm:[0,0,0,0] row_mask:0xf bank_mask:0xf
    v_add_f32_dpp v8, v65, v8 quad_perm:[1,1,1,1] row_mask:0xf bank_mask:0xf
    v_add_f32_dpp v9, v69, v9 quad_perm:[1,1,1,1] row_mask:0xf bank_mask:0xf
    v_add_f32_dpp v10, v73, v10 quad_perm:[1,1,1,1] row_mask:0xf bank_mask:0xf
    v_add_f32_dpp v11, v77, v11 quad_perm:[1,1,1,1] row_mask:0xf bank_mask:0xf
    v_add_f32_dpp v12, v81, v12 quad_perm:[1,1,1,1] row_mask:0xf bank_mask:0xf
    v_add_f32_dpp v13, v85, v13 quad_perm:[1,1,1,1] row_mask:0xf bank_mask:0xf
    v_add_f32_dpp v14, v89, v14 quad_perm:[1,1,1,1] row_mask:0xf bank_mask:0xf
    v_add_f32_dpp v15, v93, v15 quad_perm:[1,1,1,1] row_mask:0xf bank_mask:0xf
    v_add_f32_dpp v8, v66, v8 quad_perm:[2,2,2,2] row_mask:0xf bank_mask:0xf
    v_add_f32_dpp v9, v70, v9 quad_perm:[2,2,2,2] row_mask:0xf bank_mask:0xf
    v_add_f32_dpp v10, v74, v10 quad_perm:[2,2,2,2] row_mask:0xf bank_mask:0xf
    v_add_f32_dpp v11, v78, v11 quad_perm:[2,2,2,2] row_mask:0xf bank_mask:0xf
    v_add_f32_dpp v12, v82, v12 quad_perm:[2,2,2,2] row_mask:0xf bank_mask:0xf
    v_add_f32_dpp v13, v86, v13 quad_perm:[2,2,2,2] row_mask:0xf bank_mask:0xf
    v_add_f32_dpp v14, v90, v14 quad_perm:[2,2,2,2] row_mask:0xf bank_mask:0xf
    v_add_f32_dpp v15, v94, v15 quad_perm:[2,2,2,2] row_mask:0xf bank_mask:0xf
    v_add_f32_dpp v8, v67, v8 quad_perm:[3,3,3,3] row_mask:0xf bank_mask:0xf
    v_add_f32_dpp v9, v71, v9 quad_perm:[3,3,3,3] row_mask:0xf bank_mask:0xf
    v_add_f32_dpp v10, v75, v10 quad_perm:[3,3,3,3] row_mask:0xf bank_mask:0xf
    v_add_f32_dpp v11, v79, v11 quad_perm:[3,3,3,3] row_mask:0xf bank_mask:0xf
    v_add_f32_dpp v12, v83, v12 quad_perm:[3,3,3,3] row_mask:0xf bank_mask:0xf
    v_add_f32_dpp v13, v87, v13 quad_perm:[3,3,3,3] row_mask:0xf bank_mask:0xf
    v_add_f32_dpp v14, v91, v14 quad_perm:[3,3,3,3] row_mask:0xf bank_mask:0xf
    v_add_f32_dpp v15, v95, v15 quad_perm:[3,3,3,3] row_mask:0xf bank_mask:0xf
    v_cvt_pk_bf16_f32 v22, v8, v9
    v_cvt_pk_bf16_f32 v23, v10, v11
    v_cvt_pk_bf16_f32 v24, v12, v13
    v_cvt_pk_bf16_f32 v25, v14, v15
    v_lshlrev_b32 v8, 16, v22
    v_and_b32 v9, 0xffff0000, v22
    v_lshlrev_b32 v10, 16, v23
    v_and_b32 v11, 0xffff0000, v23
    v_lshlrev_b32 v12, 16, v24
    v_and_b32 v13, 0xffff0000, v24
    v_lshlrev_b32 v14, 16, v25
    v_and_b32 v15, 0xffff0000, v25
    v_mul_f32 v8, s38, v8
    v_mul_f32 v9, s38, v9
    v_mul_f32 v10, s38, v10
    v_mul_f32 v11, s38, v11
    v_mul_f32 v12, s38, v12
    v_mul_f32 v13, s38, v13
    v_mul_f32 v14, s38, v14
    v_mul_f32 v15, s38, v15
    v_cvt_pk_bf16_f32 v22, v8, v9
    v_cvt_pk_bf16_f32 v23, v10, v11
    v_cvt_pk_bf16_f32 v24, v12, v13
    v_cvt_pk_bf16_f32 v25, v14, v15
    v_lshlrev_b32 v8, 16, v22
    v_and_b32 v9, 0xffff0000, v22
    v_lshlrev_b32 v10, 16, v23
    v_and_b32 v11, 0xffff0000, v23
    v_lshlrev_b32 v12, 16, v24
    v_and_b32 v13, 0xffff0000, v24
    v_lshlrev_b32 v14, 16, v25
    v_and_b32 v15, 0xffff0000, v25
    v_max3_f32 v22, v8, v9, v10
    v_max3_f32 v22, v22, v11, v12
    v_max3_f32 v22, v22, v13, v14
    v_max_f32 v22, v22, v15
    v_mov_b32 v23, v22
    s_nop 1
    v_permlane16_swap_b32 v22, v23
    s_nop 1
    v_max_f32 v22, v22, v23
    v_mov_b32 v23, v22
    s_nop 1
    v_permlane32_swap_b32 v22, v23
    s_nop 1
    v_max_f32 v22, v22, v23
    v_mul_f32 v22, s28, v22
    v_max_f32 v22, v22, v20
    v_sub_f32 v23, v20, v22
    v_exp_f32 v23, v23
    v_mov_b32 v20, v22
    v_fma_f32 v8, v8, s28, -v22
    v_fma_f32 v9, v9, s28, -v22
    v_fma_f32 v10, v10, s28, -v22
    v_fma_f32 v11, v11, s28, -v22
    v_fma_f32 v12, v12, s28, -v22
    v_fma_f32 v13, v13, s28, -v22
    v_fma_f32 v14, v14, s28, -v22
    v_fma_f32 v15, v15, s28, -v22
    v_exp_f32 v8, v8
    v_exp_f32 v9, v9
    v_exp_f32 v10, v10
    v_exp_f32 v11, v11
    v_exp_f32 v12, v12
    v_exp_f32 v13, v13
    v_exp_f32 v14, v14
    v_exp_f32 v15, v15
    v_mul_f32 v21, v21, v23
    v_add_f32 v21, v21, v8
    v_add_f32 v21, v21, v9
    v_add_f32 v21, v21, v10
    v_add_f32 v21, v21, v11
    v_add_f32 v21, v21, v12
    v_add_f32 v21, v21, v13
    v_add_f32 v21, v21, v14
    v_add_f32 v21, v21, v15
    v_cvt_pk_bf16_f32 v16, v8, v9
    v_cvt_pk_bf16_f32 v17, v10, v11
    v_cvt_pk_bf16_f32 v18, v12, v13
    v_cvt_pk_bf16_f32 v19, v14, v15
    v_mul_f32 v32, v32, v23
    v_mul_f32 v33, v33, v23
    v_mul_f32 v34, v34, v23
    v_mul_f32 v35, v35, v23
    v_mul_f32 v36, v36, v23
    v_mul_f32 v37, v37, v23
    v_mul_f32 v38, v38, v23
    v_mul_f32 v39, v39, v23
    v_mul_f32 v40, v40, v23
    v_mul_f32 v41, v41, v23
    v_mul_f32 v42, v42, v23
    v_mul_f32 v43, v43, v23
    v_mul_f32 v44, v44, v23
    v_mul_f32 v45, v45, v23
    v_mul_f32 v46, v46, v23
    v_mul_f32 v47, v47, v23
    v_mul_f32 v48, v48, v23
    v_mul_f32 v49, v49, v23
    v_mul_f32 v50, v50, v23
    v_mul_f32 v51, v51, v23
    v_mul_f32 v52, v52, v23
    v_mul_f32 v53, v53, v23
    v_mul_f32 v54, v54, v23
    v_mul_f32 v55, v55, v23
    v_mul_f32 v56, v56, v23
    v_mul_f32 v57, v57, v23
    v_mul_f32 v58, v58, v23
    v_mul_f32 v59, v59, v23
    v_mul_f32 v60, v60, v23
    v_mul_f32 v61, v61, v23
    v_mul_f32 v62, v62, v23
    v_mul_f32 v63, v63, v23
    s_waitcnt vmcnt(0)
    v_perm_b32 v64, v196, v192, s26
    v_perm_b32 v65, v204, v200, s26
    v_perm_b32 v66, v212, v208, s26
    v_perm_b32 v67, v220, v216, s26
    v_perm_b32 v68, v196, v192, s27
    v_perm_b32 v69, v204, v200, s27
    v_perm_b32 v70, v212, v208, s27
    v_perm_b32 v71, v220, v216, s27
    v_perm_b32 v72, v197, v193, s26
    v_perm_b32 v73, v205, v201, s26
    v_perm_b32 v74, v213, v209, s26
    v_perm_b32 v75, v221, v217, s26
    v_perm_b32 v76, v197, v193, s27
    v_perm_b32 v77, v205, v201, s27
    v_perm_b32 v78, v213, v209, s27
    v_perm_b32 v79, v221, v217, s27
    v_perm_b32 v80, v198, v194, s26
    v_perm_b32 v81, v206, v202, s26
    v_perm_b32 v82, v214, v210, s26
    v_perm_b32 v83, v222, v218, s26
    v_perm_b32 v84, v198, v194, s27
    v_perm_b32 v85, v206, v202, s27
    v_perm_b32 v86, v214, v210, s27
    v_perm_b32 v87, v222, v218, s27
    v_perm_b32 v88, v199, v195, s26
    v_perm_b32 v89, v207, v203, s26
    v_perm_b32 v90, v215, v211, s26
    v_perm_b32 v91, v223, v219, s26
    v_perm_b32 v92, v199, v195, s27
    v_perm_b32 v93, v207, v203, s27
    v_perm_b32 v94, v215, v211, s27
    v_perm_b32 v95, v223, v219, s27
    s_nop 1
    v_mfma_f32_16x16x32_bf16 v[32:35], v[64:67], v[16:19], v[32:35]
    v_mfma_f32_16x16x32_bf16 v[36:39], v[68:71], v[16:19], v[36:39]
    v_mfma_f32_16x16x32_bf16 v[40:43], v[72:75], v[16:19], v[40:43]
    v_mfma_f32_16x16x32_bf16 v[44:47], v[76:79], v[16:19], v[44:47]
    v_mfma_f32_16x16x32_bf16 v[48:51], v[80:83], v[16:19], v[48:51]
    v_mfma_f32_16x16x32_bf16 v[52:55], v[84:87], v[16:19], v[52:55]
    v_mfma_f32_16x16x32_bf16 v[56:59], v[88:91], v[16:19], v[56:59]
    v_mfma_f32_16x16x32_bf16 v[60:63], v[92:95], v[16:19], v[60:63]
    s_waitcnt lgkmcnt(0)
    v_mov_b32 v9, 19460
K2_gate:
    ds_read_b32 v8, v9
    s_waitcnt lgkmcnt(0)
    v_readfirstlane_b32 s24, v8
    s_cmp_ge_u32 s24, 8
    s_cbranch_scc1 K2_gateopen
    s_sleep 4
    s_branch K2_gate
K2_gateopen:
    s_lshr_b32 s29, s2, 3
    s_mul_i32 s29, s29, 4352
    s_add_u32 s29, s29, 5242880
    v_mov_b32 v226, 0
    v_mov_b32 v227, 1
    s_mov_b64 exec, 1
    buffer_atomic_add v227, v226, s[20:23], s29 offen sc0
    s_mov_b64 exec, -1
K2_pool:
    s_waitcnt vmcnt(0)
    v_readfirstlane_b32 s24, v227
    s_add_u32 s24, s24, 384
    s_lshl_b32 s24, s24, 13
    s_add_u32 s25, s24, 4096
    s_cmp_ge_u32 s24, 0x400000
    s_cbranch_scc1 K2_loopend
    buffer_load_dwordx4 v[96:99], v224, s[12:15], s24 offen nt
    buffer_load_dwordx4 v[100:103], v224, s[12:15], s24 offen offset:1024 nt
    buffer_load_dwordx4 v[104:107], v224, s[12:15], s24 offen offset:2048 nt
    buffer_load_dwordx4 v[108:111], v224, s[12:15], s24 offen offset:3072 nt
    buffer_load_dwordx4 v[112:115], v224, s[12:15], s25 offen nt
    buffer_load_dwordx4 v[116:119], v224, s[12:15], s25 offen offset:1024 nt
    buffer_load_dwordx4 v[120:123], v224, s[12:15], s25 offen offset:2048 nt
    buffer_load_dwordx4 v[124:127], v224, s[12:15], s25 offen offset:3072 nt
    buffer_load_dwordx4 v[128:131], v225, s[16:19], s24 offen nt
    buffer_load_dwordx4 v[132:135], v225, s[16:19], s24 offen offset:1024 nt
    buffer_load_dwordx4 v[136:139], v225, s[16:19], s24 offen offset:2048 nt
    buffer_load_dwordx4 v[140:143], v225, s[16:19], s24 offen offset:3072 nt
    buffer_load_dwordx4 v[144:147], v225, s[16:19], s25 offen nt
    buffer_load_dwordx4 v[148:151], v225, s[16:19], s25 offen offset:1024 nt
    buffer_load_dwordx4 v[152:155], v225, s[16:19], s25 offen offset:2048 nt
    buffer_load_dwordx4 v[156:159], v225, s[16:19], s25 offen offset:3072 nt
    v_mov_b32 v227, 1
    s_mov_b64 exec, 1
    buffer_atomic_add v227, v226, s[20:23], s29 offen sc0
    s_mov_b64 exec, -1
    s_waitcnt vmcnt(16)
    v_mfma_f32_16x16x32_bf16 v[64:67], v[96:99], v[4:7], 0
    s_waitcnt vmcnt(15)
    v_mfma_f32_16x16x32_bf16 v[68:71], v[100:103], v[4:7], 0
    s_waitcnt vmcnt(14)
    v_mfma_f32_16x16x32_bf16 v[72:75], v[104:107], v[4:7], 0
    s_waitcnt vmcnt(13)
    v_mfma_f32_16x16x32_bf16 v[76:79], v[108:111], v[4:7], 0
    s_waitcnt vmcnt(12)
    v_mfma_f32_16x16x32_bf16 v[80:83], v[112:115], v[4:7], 0
    s_waitcnt vmcnt(11)
    v_mfma_f32_16x16x32_bf16 v[84:87], v[116:119], v[4:7], 0
    s_waitcnt vmcnt(10)
    v_mfma_f32_16x16x32_bf16 v[88:91], v[120:123], v[4:7], 0
    s_waitcnt vmcnt(9)
    v_mfma_f32_16x16x32_bf16 v[92:95], v[124:127], v[4:7], 0
    s_nop 7
    v_mov_b32_dpp v8, v64 quad_perm:[0,0,0,0] row_mask:0xf bank_mask:0xf
    v_mov_b32_dpp v9, v68 quad_perm:[0,0,0,0] row_mask:0xf bank_mask:0xf
    v_mov_b32_dpp v10, v72 quad_perm:[0,0,0,0] row_mask:0xf bank_mask:0xf
    v_mov_b32_dpp v11, v76 quad_perm:[0,0,0,0] row_mask:0xf bank_mask:0xf
    v_mov_b32_dpp v12, v80 quad_perm:[0,0,0,0] row_mask:0xf bank_mask:0xf
    v_mov_b32_dpp v13, v84 quad_perm:[0,0,0,0] row_mask:0xf bank_mask:0xf
    v_mov_b32_dpp v14, v88 quad_perm:[0,0,0,0] row_mask:0xf bank_mask:0xf
    v_mov_b32_dpp v15, v92 quad_perm:[0,0,0,0] row_mask:0xf bank_mask:0xf
    v_add_f32_dpp v8, v65, v8 quad_perm:[1,1,1,1] row_mask:0xf bank_mask:0xf
    v_add_f32_dpp v9, v69, v9 quad_perm:[1,1,1,1] row_mask:0xf bank_mask:0xf
    v_add_f32_dpp v10, v73, v10 quad_perm:[1,1,1,1] row_mask:0xf bank_mask:0xf
    v_add_f32_dpp v11, v77, v11 quad_perm:[1,1,1,1] row_mask:0xf bank_mask:0xf
    v_add_f32_dpp v12, v81, v12 quad_perm:[1,1,1,1] row_mask:0xf bank_mask:0xf
    v_add_f32_dpp v13, v85, v13 quad_perm:[1,1,1,1] row_mask:0xf bank_mask:0xf
    v_add_f32_dpp v14, v89, v14 quad_perm:[1,1,1,1] row_mask:0xf bank_mask:0xf
    v_add_f32_dpp v15, v93, v15 quad_perm:[1,1,1,1] row_mask:0xf bank_mask:0xf
    v_add_f32_dpp v8, v66, v8 quad_perm:[2,2,2,2] row_mask:0xf bank_mask:0xf
    v_add_f32_dpp v9, v70, v9 quad_perm:[2,2,2,2] row_mask:0xf bank_mask:0xf
    v_add_f32_dpp v10, v74, v10 quad_perm:[2,2,2,2] row_mask:0xf bank_mask:0xf
    v_add_f32_dpp v11, v78, v11 quad_perm:[2,2,2,2] row_mask:0xf bank_mask:0xf
    v_add_f32_dpp v12, v82, v12 quad_perm:[2,2,2,2] row_mask:0xf bank_mask:0xf
    v_add_f32_dpp v13, v86, v13 quad_perm:[2,2,2,2] row_mask:0xf bank_mask:0xf
    v_add_f32_dpp v14, v90, v14 quad_perm:[2,2,2,2] row_mask:0xf bank_mask:0xf
    v_add_f32_dpp v15, v94, v15 quad_perm:[2,2,2,2] row_mask:0xf bank_mask:0xf
    v_add_f32_dpp v8, v67, v8 quad_perm:[3,3,3,3] row_mask:0xf bank_mask:0xf
    v_add_f32_dpp v9, v71, v9 quad_perm:[3,3,3,3] row_mask:0xf bank_mask:0xf
    v_add_f32_dpp v10, v75, v10 quad_perm:[3,3,3,3] row_mask:0xf bank_mask:0xf
    v_add_f32_dpp v11, v79, v11 quad_perm:[3,3,3,3] row_mask:0xf bank_mask:0xf
    v_add_f32_dpp v12, v83, v12 quad_perm:[3,3,3,3] row_mask:0xf bank_mask:0xf
    v_add_f32_dpp v13, v87, v13 quad_perm:[3,3,3,3] row_mask:0xf bank_mask:0xf
    v_add_f32_dpp v14, v91, v14 quad_perm:[3,3,3,3] row_mask:0xf bank_mask:0xf
    v_add_f32_dpp v15, v95, v15 quad_perm:[3,3,3,3] row_mask:0xf bank_mask:0xf
    v_cvt_pk_bf16_f32 v22, v8, v9
    v_cvt_pk_bf16_f32 v23, v10, v11
    v_cvt_pk_bf16_f32 v24, v12, v13
    v_cvt_pk_bf16_f32 v25, v14, v15
    v_lshlrev_b32 v8, 16, v22
    v_and_b32 v9, 0xffff0000, v22
    v_lshlrev_b32 v10, 16, v23
    v_and_b32 v11, 0xffff0000, v23
    v_lshlrev_b32 v12, 16, v24
    v_and_b32 v13, 0xffff0000, v24
    v_lshlrev_b32 v14, 16, v25
    v_and_b32 v15, 0xffff0000, v25
    v_mul_f32 v8, s38, v8
    v_mul_f32 v9, s38, v9
    v_mul_f32 v10, s38, v10
    v_mul_f32 v11, s38, v11
    v_mul_f32 v12, s38, v12
    v_mul_f32 v13, s38, v13
    v_mul_f32 v14, s38, v14
    v_mul_f32 v15, s38, v15
    v_cvt_pk_bf16_f32 v22, v8, v9
    v_cvt_pk_bf16_f32 v23, v10, v11
    v_cvt_pk_bf16_f32 v24, v12, v13
    v_cvt_pk_bf16_f32 v25, v14, v15
    v_lshlrev_b32 v8, 16, v22
    v_and_b32 v9, 0xffff0000, v22
    v_lshlrev_b32 v10, 16, v23
    v_and_b32 v11, 0xffff0000, v23
    v_lshlrev_b32 v12, 16, v24
    v_and_b32 v13, 0xffff0000, v24
    v_lshlrev_b32 v14, 16, v25
    v_and_b32 v15, 0xffff0000, v25
    v_max3_f32 v22, v8, v9, v10
    v_max3_f32 v22, v22, v11, v12
    v_max3_f32 v22, v22, v13, v14
    v_max_f32 v22, v22, v15
    v_mov_b32 v23, v22
    s_nop 1
    v_permlane16_swap_b32 v22, v23
    s_nop 1
    v_max_f32 v22, v22, v23
    v_mov_b32 v23, v22
    s_nop 1
    v_permlane32_swap_b32 v22, v23
    s_nop 1
    v_max_f32 v22, v22, v23
    v_mul_f32 v22, s28, v22
    v_max_f32 v22, v22, v20
    v_sub_f32 v23, v20, v22
    v_exp_f32 v23, v23
    v_mov_b32 v20, v22
    v_fma_f32 v8, v8, s28, -v22
    v_fma_f32 v9, v9, s28, -v22
    v_fma_f32 v10, v10, s28, -v22
    v_fma_f32 v11, v11, s28, -v22
    v_fma_f32 v12, v12, s28, -v22
    v_fma_f32 v13, v13, s28, -v22
    v_fma_f32 v14, v14, s28, -v22
    v_fma_f32 v15, v15, s28, -v22
    v_exp_f32 v8, v8
    v_exp_f32 v9, v9
    v_exp_f32 v10, v10
    v_exp_f32 v11, v11
    v_exp_f32 v12, v12
    v_exp_f32 v13, v13
    v_exp_f32 v14, v14
    v_exp_f32 v15, v15
    v_mul_f32 v21, v21, v23
    v_add_f32 v21, v21, v8
    v_add_f32 v21, v21, v9
    v_add_f32 v21, v21, v10
    v_add_f32 v21, v21, v11
    v_add_f32 v21, v21, v12
    v_add_f32 v21, v21, v13
    v_add_f32 v21, v21, v14
    v_add_f32 v21, v21, v15
    v_cvt_pk_bf16_f32 v16, v8, v9
    v_cvt_pk_bf16_f32 v17, v10, v11
    v_cvt_pk_bf16_f32 v18, v12, v13
    v_cvt_pk_bf16_f32 v19, v14, v15
    v_mul_f32 v32, v32, v23
    v_mul_f32 v33, v33, v23
    v_mul_f32 v34, v34, v23
    v_mul_f32 v35, v35, v23
    v_mul_f32 v36, v36, v23
    v_mul_f32 v37, v37, v23
    v_mul_f32 v38, v38, v23
    v_mul_f32 v39, v39, v23
    v_mul_f32 v40, v40, v23
    v_mul_f32 v41, v41, v23
    v_mul_f32 v42, v42, v23
    v_mul_f32 v43, v43, v23
    v_mul_f32 v44, v44, v23
    v_mul_f32 v45, v45, v23
    v_mul_f32 v46, v46, v23
    v_mul_f32 v47, v47, v23
    v_mul_f32 v48, v48, v23
    v_mul_f32 v49, v49, v23
    v_mul_f32 v50, v50, v23
    v_mul_f32 v51, v51, v23
    v_mul_f32 v52, v52, v23
    v_mul_f32 v53, v53, v23
    v_mul_f32 v54, v54, v23
    v_mul_f32 v55, v55, v23
    v_mul_f32 v56, v56, v23
    v_mul_f32 v57, v57, v23
    v_mul_f32 v58, v58, v23
    v_mul_f32 v59, v59, v23
    v_mul_f32 v60, v60, v23
    v_mul_f32 v61, v61, v23
    v_mul_f32 v62, v62, v23
    v_mul_f32 v63, v63, v23
    s_waitcnt vmcnt(1)
    v_perm_b32 v64, v132, v128, s26
    v_perm_b32 v65, v140, v136, s26
    v_perm_b32 v66, v148, v144, s26
    v_perm_b32 v67, v156, v152, s26
    v_perm_b32 v68, v132, v128, s27
    v_perm_b32 v69, v140, v136, s27
    v_perm_b32 v70, v148, v144, s27
    v_perm_b32 v71, v156, v152, s27
    v_perm_b32 v72, v133, v129, s26
    v_perm_b32 v73, v141, v137, s26
    v_perm_b32 v74, v149, v145, s26
    v_perm_b32 v75, v157, v153, s26
    v_perm_b32 v76, v133, v129, s27
    v_perm_b32 v77, v141, v137, s27
    v_perm_b32 v78, v149, v145, s27
    v_perm_b32 v79, v157, v153, s27
    v_perm_b32 v80, v134, v130, s26
    v_perm_b32 v81, v142, v138, s26
    v_perm_b32 v82, v150, v146, s26
    v_perm_b32 v83, v158, v154, s26
    v_perm_b32 v84, v134, v130, s27
    v_perm_b32 v85, v142, v138, s27
    v_perm_b32 v86, v150, v146, s27
    v_perm_b32 v87, v158, v154, s27
    v_perm_b32 v88, v135, v131, s26
    v_perm_b32 v89, v143, v139, s26
    v_perm_b32 v90, v151, v147, s26
    v_perm_b32 v91, v159, v155, s26
    v_perm_b32 v92, v135, v131, s27
    v_perm_b32 v93, v143, v139, s27
    v_perm_b32 v94, v151, v147, s27
    v_perm_b32 v95, v159, v155, s27
    s_nop 1
    v_mfma_f32_16x16x32_bf16 v[32:35], v[64:67], v[16:19], v[32:35]
    v_mfma_f32_16x16x32_bf16 v[36:39], v[68:71], v[16:19], v[36:39]
    v_mfma_f32_16x16x32_bf16 v[40:43], v[72:75], v[16:19], v[40:43]
    v_mfma_f32_16x16x32_bf16 v[44:47], v[76:79], v[16:19], v[44:47]
    v_mfma_f32_16x16x32_bf16 v[48:51], v[80:83], v[16:19], v[48:51]
    v_mfma_f32_16x16x32_bf16 v[52:55], v[84:87], v[16:19], v[52:55]
    v_mfma_f32_16x16x32_bf16 v[56:59], v[88:91], v[16:19], v[56:59]
    v_mfma_f32_16x16x32_bf16 v[60:63], v[92:95], v[16:19], v[60:63]
    s_branch K2_pool
K2_loopend:
    s_waitcnt lgkmcnt(0)
    s_cmp_ge_u32 s57, 92
    s_cbranch_scc1 T_now
    s_and_b32 s76, s57, 3
    s_lshr_b32 s77, s57, 2
    s_cmp_ge_u32 s57, 64
    s_cbranch_scc1 T_wmlp
    s_mov_b32 s68, s48
    s_and_b32 s69, s49, 0xffff
    s_mov_b32 s70, 0x400000
    s_mov_b32 s71, 0x00020000
    s_mov_b32 s78, s77
    s_branch T_wgo
T_wmlp:
    s_mov_b32 s68, s50
    s_and_b32 s69, s51, 0xffff
    s_mov_b32 s70, 0x1c0000
    s_mov_b32 s71, 0x00020000
    s_sub_u32 s78, s77, 16
T_wgo:
    s_lshl_b32 s79, s78, 8
    s_lshl_b32 s80, s30, 5
    s_add_u32 s79, s79, s80
    v_lshrrev_b32 v22, 4, v3
    v_lshlrev_b32 v22, 3, v22
    v_add_u32 v22, s79, v22
    v_lshlrev_b32 v22, 10, v22
    v_and_b32 v23, 15, v3
    v_lshlrev_b32 v23, 4, v23
    s_lshl_b32 s80, s76, 8
    v_add3_u32 v22, v22, v23, s80
    s_mov_b32 s80, 4096
    buffer_load_dwordx4 v[96:99], v22, s[68:71], 0 offen offset:0 nt
    buffer_load_dwordx4 v[100:103], v22, s[68:71], 0 offen offset:1024 nt
    buffer_load_dwordx4 v[104:107], v22, s[68:71], 0 offen offset:2048 nt
    buffer_load_dwordx4 v[108:111], v22, s[68:71], 0 offen offset:3072 nt
    buffer_load_dwordx4 v[112:115], v22, s[68:71], s80 offen offset:0 nt
    buffer_load_dwordx4 v[116:119], v22, s[68:71], s80 offen offset:1024 nt
    buffer_load_dwordx4 v[120:123], v22, s[68:71], s80 offen offset:2048 nt
    buffer_load_dwordx4 v[124:127], v22, s[68:71], s80 offen offset:3072 nt
T_now:
    s_lshl_b32 s87, s57, 2
    s_add_u32 s87, s87, s30
    s_and_b32 s87, s87, 255
    s_mov_b32 s64, s10
    s_and_b32 s65, s11, 0xffff
    s_mov_b32 s66, 0x1000
    s_mov_b32 s67, 0x00020000
    s_mov_b32 s72, s52
    s_and_b32 s73, s53, 0xffff
    s_mov_b32 s74, 0x400
    s_mov_b32 s75, 0x00020000
    v_and_b32 v22, 3, v3
    v_lshlrev_b32 v22, 2, v22
    s_lshl_b32 s80, s87, 4
    buffer_load_dword v228, v22, s[64:67], s80 offen
    s_and_b32 s81, s80, 1023
    buffer_load_dword v229, v22, s[72:75], s81 offen
    v_mov_b32 v23, v21
    s_nop 1
    v_permlane16_swap_b32 v21, v23
    s_nop 1
    v_add_f32 v21, v21, v23
    v_mov_b32 v23, v21
    s_nop 1
    v_permlane32_swap_b32 v21, v23
    s_nop 1
    v_add_f32 v21, v21, v23
    s_nop 7
    v_cndmask_b32 v8, v32, v33, s[32:33]
    v_cndmask_b32 v8, v8, v34, s[34:35]
    v_cndmask_b32 v8, v8, v35, s[36:37]
    v_cndmask_b32 v9, v36, v37, s[32:33]
    v_cndmask_b32 v9, v9, v38, s[34:35]
    v_cndmask_b32 v9, v9, v39, s[36:37]
    v_cndmask_b32 v10, v40, v41, s[32:33]
    v_cndmask_b32 v10, v10, v42, s[34:35]
    v_cndmask_b32 v10, v10, v43, s[36:37]
    v_cndmask_b32 v11, v44, v45, s[32:33]
    v_cndmask_b32 v11, v11, v46, s[34:35]
    v_cndmask_b32 v11, v11, v47, s[36:37]
    v_cndmask_b32 v12, v48, v49, s[32:33]
    v_cndmask_b32 v12, v12, v50, s[34:35]
    v_cndmask_b32 v12, v12, v51, s[36:37]
    v_cndmask_b32 v13, v52, v53, s[32:33]
    v_cndmask_b32 v13, v13, v54, s[34:35]
    v_cndmask_b32 v13, v13, v55, s[36:37]
    v_cndmask_b32 v14, v56, v57, s[32:33]
    v_cndmask_b32 v14, v14, v58, s[34:35]
    v_cndmask_b32 v14, v14, v59, s[36:37]
    v_cndmask_b32 v15, v60, v61, s[32:33]
    v_cndmask_b32 v15, v15, v62, s[34:35]
    v_cndmask_b32 v15, v15, v63, s[36:37]
    s_lshl_b32 s31, s30, 11
    v_lshlrev_b32 v22, 1, v224
    v_add_u32 v22, s31, v22
    ds_write_b128 v22, v[8:11]
    ds_write_b128 v22, v[12:15] offset:16
    v_bfe_u32 v23, v3, 2, 2
    v_lshlrev_b32 v23, 3, v23
    s_lshl_b32 s31, s30, 5
    v_add_u32 v23, s31, v23
    ds_write_b64 v23, v[20:21] offset:16384
    s_waitcnt lgkmcnt(0)
    s_barrier
    v_lshrrev_b32 v22, 7, v0
    v_lshlrev_b32 v22, 3, v22
    v_lshlrev_b32 v23, 2, v0
    ds_read_b64 v[32:33], v22 offset:16384
    ds_read_b64 v[34:35], v22 offset:16416
    ds_read_b64 v[36:37], v22 offset:16448
    ds_read_b64 v[38:39], v22 offset:16480
    ds_read_b64 v[40:41], v22 offset:16512
    ds_read_b64 v[42:43], v22 offset:16544
    ds_read_b64 v[44:45], v22 offset:16576
    ds_read_b64 v[46:47], v22 offset:16608
    ds_read_b32 v48, v23 offset:0
    ds_read_b32 v49, v23 offset:2048
    ds_read_b32 v50, v23 offset:4096
    ds_read_b32 v51, v23 offset:6144
    ds_read_b32 v52, v23 offset:8192
    ds_read_b32 v53, v23 offset:10240
    ds_read_b32 v54, v23 offset:12288
    ds_read_b32 v55, v23 offset:14336
    s_waitcnt lgkmcnt(0)
    v_max3_f32 v24, v32, v34, v36
    v_max3_f32 v24, v24, v38, v40
    v_max3_f32 v24, v24, v42, v44
    v_max_f32 v24, v24, v46
    v_sub_f32 v32, v32, v24
    v_sub_f32 v34, v34, v24
    v_sub_f32 v36, v36, v24
    v_sub_f32 v38, v38, v24
    v_sub_f32 v40, v40, v24
    v_sub_f32 v42, v42, v24
    v_sub_f32 v44, v44, v24
    v_sub_f32 v46, v46, v24
    v_exp_f32 v32, v32
    v_exp_f32 v34, v34
    v_exp_f32 v36, v36
    v_exp_f32 v38, v38
    v_exp_f32 v40, v40
    v_exp_f32 v42, v42
    v_exp_f32 v44, v44
    v_exp_f32 v46, v46
    s_nop 0
    v_mul_f32 v26, v32, v33
    v_mul_f32 v28, v32, v48
    v_fmac_f32 v26, v34, v35
    v_fmac_f32 v28, v34, v49
    v_fmac_f32 v26, v36, v37
    v_fmac_f32 v28, v36, v50
    v_fmac_f32 v26, v38, v39
    v_fmac_f32 v28, v38, v51
    v_fmac_f32 v26, v40, v41
    v_fmac_f32 v28, v40, v52
    v_fmac_f32 v26, v42, v43
    v_fmac_f32 v28, v42, v53
    v_fmac_f32 v26, v44, v45
    v_fmac_f32 v28, v44, v54
    v_fmac_f32 v26, v46, v47
    v_fmac_f32 v28, v46, v55
    v_mov_b32 v25, s39
    v_mov_b32 v27, s39
    v_mov_b32 v29, s39
    s_lshl_b32 s31, s2, 12
    s_add_u32 s31, s31, 3145728
    v_lshlrev_b32 v23, 3, v0
    buffer_store_dwordx2 v[28:29], v23, s[20:23], s31 offen sc0 sc1
    v_and_b32 v30, 127, v0
    v_cmp_eq_u32 vcc, 0, v30
    s_lshl_b32 s31, s2, 6
    s_add_u32 s31, s31, 4194304
    v_lshlrev_b32 v22, 1, v22
    s_and_saveexec_b64 s[40:41], vcc
    s_cbranch_execz T_skipml
    buffer_store_dwordx4 v[24:27], v22, s[20:23], s31 offen sc0 sc1
T_skipml:
    s_mov_b64 exec, s[40:41]
    s_cmp_ge_u32 s57, 92
    s_cbranch_scc1 K2_fin
    s_mov_b32 s40, 0x05040100
    s_mov_b32 s41, 0x07060302
    s_waitcnt vmcnt(0)
    v_perm_b32 v128, v100, v96, s40
    v_perm_b32 v129, v108, v104, s40
    v_perm_b32 v130, v116, v112, s40
    v_perm_b32 v131, v124, v120, s40
    v_perm_b32 v132, v100, v96, s41
    v_perm_b32 v133, v108, v104, s41
    v_perm_b32 v134, v116, v112, s41
    v_perm_b32 v135, v124, v120, s41
    v_perm_b32 v136, v101, v97, s40
    v_perm_b32 v137, v109, v105, s40
    v_perm_b32 v138, v117, v113, s40
    v_perm_b32 v139, v125, v121, s40
    v_perm_b32 v140, v101, v97, s41
    v_perm_b32 v141, v109, v105, s41
    v_perm_b32 v142, v117, v113, s41
    v_perm_b32 v143, v125, v121, s41
    v_perm_b32 v144, v102, v98, s40
    v_perm_b32 v145, v110, v106, s40
    v_perm_b32 v146, v118, v114, s40
    v_perm_b32 v147, v126, v122, s40
    v_perm_b32 v148, v102, v98, s41
    v_perm_b32 v149, v110, v106, s41
    v_perm_b32 v150, v118, v114, s41
    v_perm_b32 v151, v126, v122, s41
    v_perm_b32 v152, v103, v99, s40
    v_perm_b32 v153, v111, v107, s40
    v_perm_b32 v154, v119, v115, s40
    v_perm_b32 v155, v127, v123, s40
    v_perm_b32 v156, v103, v99, s41
    v_perm_b32 v157, v111, v107, s41
    v_perm_b32 v158, v119, v115, s41
    v_perm_b32 v159, v127, v123, s41
    s_cmp_ge_u32 s57, 64
    s_cbranch_scc1 T1_mlp
    s_lshr_b32 s79, s30, 2
    s_lshl_b32 s80, s78, 1
    s_add_u32 s79, s79, s80
    s_and_b32 s80, s30, 3
    s_lshl_b32 s80, s80, 3
    s_lshr_b32 s81, s79, 2
    s_add_u32 s80, s80, s81
    s_lshl_b32 s80, s80, 3
    s_and_b32 s79, s79, 3
    s_lshl_b32 s81, s80, 12
    s_lshl_b32 s82, s79, 10
    s_add_u32 s81, s81, s82
    s_add_u32 s81, s81, 3145728
    s_lshl_b32 s82, s80, 6
    s_lshl_b32 s83, s79, 4
    s_add_u32 s82, s82, s83
    s_add_u32 s82, s82, 4194304
    v_lshlrev_b32 v22, 4, v3
    v_lshlrev_b32 v23, 6, v3
    s_mov_b64 exec, 0xff
T1_hint:
    buffer_load_dwordx4 v[64:67], v23, s[20:23], s82 offen sc0 sc1
    s_waitcnt vmcnt(0)
    v_cmp_ne_u32 vcc, s39, v65
    v_cmp_ne_u32 s[84:85], s39, v67
    s_or_b64 vcc, vcc, s[84:85]
    s_bcnt1_i32_b64 s84, vcc
    s_cmp_le_u32 s84, 1
    s_cbranch_scc1 T1_hintdone
    s_sleep 8
    s_branch T1_hint
T1_hintdone:
    s_mov_b64 exec, -1
    v_mov_b32 v23, 0
T1_poll:
    s_mov_b32 s83, s81
    buffer_load_dwordx4 v[64:67], v23, s[20:23], s82 offen offset:0 sc0 sc1
    buffer_load_dwordx4 v[68:71], v23, s[20:23], s82 offen offset:64 sc0 sc1
    buffer_load_dwordx4 v[72:75], v23, s[20:23], s82 offen offset:128 sc0 sc1
    buffer_load_dwordx4 v[76:79], v23, s[20:23], s82 offen offset:192 sc0 sc1
    buffer_load_dwordx4 v[80:83], v23, s[20:23], s82 offen offset:256 sc0 sc1
    buffer_load_dwordx4 v[84:87], v23, s[20:23], s82 offen offset:320 sc0 sc1
    buffer_load_dwordx4 v[88:91], v23, s[20:23], s82 offen offset:384 sc0 sc1
    buffer_load_dwordx4 v[92:95], v23, s[20:23], s82 offen offset:448 sc0 sc1
    buffer_load_dwordx4 v[32:35], v22, s[20:23], s83 offen sc0 sc1
    s_add_u32 s83, s83, 4096
    buffer_load_dwordx4 v[36:39], v22, s[20:23], s83 offen sc0 sc1
    s_add_u32 s83, s83, 4096
    buffer_load_dwordx4 v[40:43], v22, s[20:23], s83 offen sc0 sc1
    s_add_u32 s83, s83, 4096
    buffer_load_dwordx4 v[44:47], v22, s[20:23], s83 offen sc0 sc1
    s_add_u32 s83, s83, 4096
    buffer_load_dwordx4 v[48:51], v22, s[20:23], s83 offen sc0 sc1
    s_add_u32 s83, s83, 4096
    buffer_load_dwordx4 v[52:55], v22, s[20:23], s83 offen sc0 sc1
    s_add_u32 s83, s83, 4096
    buffer_load_dwordx4 v[56:59], v22, s[20:23], s83 offen sc0 sc1
    s_add_u32 s83, s83, 4096
    buffer_load_dwordx4 v[60:63], v22, s[20:23], s83 offen sc0 sc1
    s_waitcnt vmcnt(0)
    v_min_u32 v4, v33, v35
    v_max_u32 v5, v33, v35
    v_min3_u32 v4, v4, v37, v39
    v_max3_u32 v5, v5, v37, v39
    v_min3_u32 v4, v4, v41, v43
    v_max3_u32 v5, v5, v41, v43
    v_min3_u32 v4, v4, v45, v47
    v_max3_u32 v5, v5, v45, v47
    v_min3_u32 v4, v4, v49, v51
    v_max3_u32 v5, v5, v49, v51
    v_min3_u32 v4, v4, v53, v55
    v_max3_u32 v5, v5, v53, v55
    v_min3_u32 v4, v4, v57, v59
    v_max3_u32 v5, v5, v57, v59
    v_min3_u32 v4, v4, v61, v63
    v_max3_u32 v5, v5, v61, v63
    v_min3_u32 v4, v4, v65, v67
    v_max3_u32 v5, v5, v65, v67
    v_min3_u32 v4, v4, v69, v71
    v_max3_u32 v5, v5, v69, v71
    v_min3_u32 v4, v4, v73, v75
    v_max3_u32 v5, v5, v73, v75
    v_min3_u32 v4, v4, v77, v79
    v_max3_u32 v5, v5, v77, v79
    v_min3_u32 v4, v4, v81, v83
    v_max3_u32 v5, v5, v81, v83
    v_min3_u32 v4, v4, v85, v87
    v_max3_u32 v5, v5, v85, v87
    v_min3_u32 v4, v4, v89, v91
    v_max3_u32 v5, v5, v89, v91
    v_min3_u32 v4, v4, v93, v95
    v_max3_u32 v5, v5, v93, v95
    v_cmp_ne_u32 vcc, s39, v4
    v_cmp_ne_u32 s[84:85], s39, v5
    s_or_b64 vcc, vcc, s[84:85]
    s_cbranch_scc0 T1_got
    s_sleep 4
    s_branch T1_poll
T1_got:
    v_max3_f32 v24, v64, v68, v72
    v_max3_f32 v24, v24, v76, v80
    v_max3_f32 v24, v24, v84, v88
    v_max_f32 v24, v24, v92
    v_sub_f32 v64, v64, v24
    v_sub_f32 v68, v68, v24
    v_sub_f32 v72, v72, v24
    v_sub_f32 v76, v76, v24
    v_sub_f32 v80, v80, v24
    v_sub_f32 v84, v84, v24
    v_sub_f32 v88, v88, v24
    v_sub_f32 v92, v92, v24
    v_exp_f32 v64, v64
    v_exp_f32 v68, v68
    v_exp_f32 v72, v72
    v_exp_f32 v76, v76
    v_exp_f32 v80, v80
    v_exp_f32 v84, v84
    v_exp_f32 v88, v88
    v_exp_f32 v92, v92
    s_nop 0
    v_mul_f32 v25, v64, v66
    v_mul_f32 v26, v64, v32
    v_mul_f32 v27, v64, v34
    v_fmac_f32 v25, v68, v70
    v_fmac_f32 v26, v68, v36
    v_fmac_f32 v27, v68, v38
    v_fmac_f32 v25, v72, v74
    v_fmac_f32 v26, v72, v40
    v_fmac_f32 v27, v72, v42
    v_fmac_f32 v25, v76, v78
    v_fmac_f32 v26, v76, v44
    v_fmac_f32 v27, v76, v46
    v_fmac_f32 v25, v80, v82
    v_fmac_f32 v26, v80, v48
    v_fmac_f32 v27, v80, v50
    v_fmac_f32 v25, v84, v86
    v_fmac_f32 v26, v84, v52
    v_fmac_f32 v27, v84, v54
    v_fmac_f32 v25, v88, v90
    v_fmac_f32 v26, v88, v56
    v_fmac_f32 v27, v88, v58
    v_fmac_f32 v25, v92, v94
    v_fmac_f32 v26, v92, v60
    v_fmac_f32 v27, v92, v62
    v_rcp_f32 v25, v25
    s_nop 0
    v_mul_f32 v26, v26, v25
    v_mul_f32 v27, v27, v25
    v_cvt_pk_bf16_f32 v26, v26, v27
    s_and_b32 s80, s30, 3
    s_lshl_b32 s80, s80, 9
    s_lshr_b32 s81, s30, 2
    s_lshl_b32 s81, s81, 8
    s_add_u32 s80, s80, s81
    s_branch T1_A
T1_mlp:
    v_lshrrev_b32 v22, 7, v0
    v_mul_u32_u24 v22, 7168, v22
    v_and_b32 v23, 127, v0
    v_lshl_add_u32 v22, v23, 3, v22
    s_lshl_b32 s81, s78, 10
    s_add_u32 s81, s81, 2228224
T1_mpoll:
    buffer_load_dwordx2 v[26:27], v22, s[20:23], s81 offen sc0 sc1
    s_waitcnt vmcnt(0)
    v_cmp_ne_u32 vcc, s39, v27
    s_cmp_eq_u64 vcc, 0
    s_cbranch_scc1 T1_mgot
    s_sleep 4
    s_branch T1_mpoll
T1_mgot:
    s_lshl_b32 s80, s30, 8
T1_A:
    v_lshlrev_b32 v22, 2, v3
    v_add_u32 v22, s80, v22
    ds_write_b32 v22, v26 offset:20480
    s_waitcnt lgkmcnt(0)
    s_barrier
    v_and_b32 v22, 3, v3
    v_lshlrev_b32 v22, 9, v22
    v_lshrrev_b32 v23, 4, v3
    v_lshl_add_u32 v22, v23, 4, v22
    s_lshl_b32 s80, s30, 6
    v_add_u32 v22, s80, v22
    ds_read_b128 v[8:11], v22 offset:20480
    s_waitcnt lgkmcnt(0)
    v_mfma_f32_16x16x32_bf16 v[32:35], v[8:11], v[128:131], 0
    v_mfma_f32_16x16x32_bf16 v[36:39], v[8:11], v[132:135], 0
    v_mfma_f32_16x16x32_bf16 v[40:43], v[8:11], v[136:139], 0
    v_mfma_f32_16x16x32_bf16 v[44:47], v[8:11], v[140:143], 0
    v_mfma_f32_16x16x32_bf16 v[48:51], v[8:11], v[144:147], 0
    v_mfma_f32_16x16x32_bf16 v[52:55], v[8:11], v[148:151], 0
    v_mfma_f32_16x16x32_bf16 v[56:59], v[8:11], v[152:155], 0
    v_mfma_f32_16x16x32_bf16 v[60:63], v[8:11], v[156:159], 0
    v_lshlrev_b32 v22, 9, v23
    v_and_b32 v23, 15, v3
    v_lshl_add_u32 v22, v23, 5, v22
    s_lshl_b32 s80, s30, 11
    v_add_u32 v22, s80, v22
    s_nop 4
    v_cndmask_b32 v24, v32, v33, s[42:43]
    v_cndmask_b32 v24, v24, v34, s[44:45]
    v_cndmask_b32 v24, v24, v35, s[46:47]
    v_cndmask_b32 v25, v36, v37, s[42:43]
    v_cndmask_b32 v25, v25, v38, s[44:45]
    v_cndmask_b32 v25, v25, v39, s[46:47]
    v_cndmask_b32 v26, v40, v41, s[42:43]
    v_cndmask_b32 v26, v26, v42, s[44:45]
    v_cndmask_b32 v26, v26, v43, s[46:47]
    v_cndmask_b32 v27, v44, v45, s[42:43]
    v_cndmask_b32 v27, v27, v46, s[44:45]
    v_cndmask_b32 v27, v27, v47, s[46:47]
    v_cndmask_b32 v28, v48, v49, s[42:43]
    v_cndmask_b32 v28, v28, v50, s[44:45]
    v_cndmask_b32 v28, v28, v51, s[46:47]
    v_cndmask_b32 v29, v52, v53, s[42:43]
    v_cndmask_b32 v29, v29, v54, s[44:45]
    v_cndmask_b32 v29, v29, v55, s[46:47]
    v_cndmask_b32 v30, v56, v57, s[42:43]
    v_cndmask_b32 v30, v30, v58, s[44:45]
    v_cndmask_b32 v30, v30, v59, s[46:47]
    v_cndmask_b32 v31, v60, v61, s[42:43]
    v_cndmask_b32 v31, v31, v62, s[44:45]
    v_cndmask_b32 v31, v31, v63, s[46:47]
    ds_write_b128 v22, v[24:27] offset:24576
    ds_write_b128 v22, v[28:31] offset:24592
    s_waitcnt lgkmcnt(0)
    s_barrier
    v_lshlrev_b32 v22, 2, v0
    ds_read_b32 v32, v22 offset:24576
    ds_read_b32 v33, v22 offset:26624
    ds_read_b32 v34, v22 offset:28672
    ds_read_b32 v35, v22 offset:30720
    ds_read_b32 v36, v22 offset:32768
    ds_read_b32 v37, v22 offset:34816
    ds_read_b32 v38, v22 offset:36864
    ds_read_b32 v39, v22 offset:38912
    v_lshrrev_b32 v23, 7, v0
    v_lshlrev_b32 v23, 12, v23
    v_and_b32 v24, 127, v0
    v_lshl_add_u32 v23, v24, 3, v23
    s_lshl_b32 s80, s77, 14
    s_lshl_b32 s81, s76, 10
    s_add_u32 s80, s80, s81
    s_add_u32 s80, s80, 4259840
    s_waitcnt lgkmcnt(0)
    v_add_f32 v32, v32, v33
    v_add_f32 v34, v34, v35
    v_add_f32 v36, v36, v37
    v_add_f32 v38, v38, v39
    v_add_f32 v32, v32, v34
    v_add_f32 v36, v36, v38
    v_add_f32 v32, v32, v36
    v_mov_b32 v33, s39
    buffer_store_dwordx2 v[32:33], v23, s[20:23], s80 offen sc0 sc1
T2:
    s_cmp_ge_u32 s57, 64
    s_cbranch_scc1 K2_fin
    s_cmp_ge_u32 s30, 4
    s_cbranch_scc1 K2_fin
    v_lshrrev_b32 v22, 2, v3
    v_and_b32 v23, 3, v3
    v_lshlrev_b32 v23, 4, v23
    v_lshl_add_u32 v24, v22, 14, v23
    v_min_u32 v25, 6, v22
    v_lshl_add_u32 v25, v25, 14, v23
    v_cmp_gt_u32 s[82:83], 7, v22
    s_lshl_b32 s80, s87, 6
    s_add_u32 s80, s80, 4259840
    s_add_u32 s81, s80, 262144
    s_branch T2_poll
    s_mov_b64 exec, 1
T2_hint:
    buffer_load_dwordx2 v[32:33], v24, s[20:23], s80 offen sc0 sc1
    s_waitcnt vmcnt(0)
    v_cmp_ne_u32 vcc, s39, v33
    s_cmp_eq_u64 vcc, 0
    s_cbranch_scc1 T2_hintdone
    s_sleep 8
    s_branch T2_hint
T2_hintdone:
    s_mov_b64 exec, -1
T2_poll:
    buffer_load_dwordx4 v[32:35], v24, s[20:23], s80 offen sc0 sc1
    buffer_load_dwordx4 v[36:39], v25, s[20:23], s81 offen sc0 sc1
    s_waitcnt vmcnt(0)
    v_min_u32 v4, v33, v35
    v_min3_u32 v4, v4, v37, v39
    v_max_u32 v5, v33, v35
    v_max3_u32 v5, v5, v37, v39
    v_cmp_ne_u32 vcc, s39, v4
    v_cmp_ne_u32 s[84:85], s39, v5
    s_or_b64 vcc, vcc, s[84:85]
    s_cbranch_scc0 T2_got
    s_sleep 1
    s_branch T2_poll
T2_got:
    v_cndmask_b32 v36, 0, v36, s[82:83]
    v_cndmask_b32 v38, 0, v38, s[82:83]
    s_nop 1
    v_add_f32_dpp v32, v32, v32 row_ror:4 row_mask:0xf bank_mask:0xf
    v_add_f32_dpp v34, v34, v34 row_ror:4 row_mask:0xf bank_mask:0xf
    v_add_f32_dpp v36, v36, v36 row_ror:4 row_mask:0xf bank_mask:0xf
    v_add_f32_dpp v38, v38, v38 row_ror:4 row_mask:0xf bank_mask:0xf
    s_nop 1
    v_add_f32_dpp v32, v32, v32 row_ror:8 row_mask:0xf bank_mask:0xf
    v_add_f32_dpp v34, v34, v34 row_ror:8 row_mask:0xf bank_mask:0xf
    v_add_f32_dpp v36, v36, v36 row_ror:8 row_mask:0xf bank_mask:0xf
    v_add_f32_dpp v38, v38, v38 row_ror:8 row_mask:0xf bank_mask:0xf
    v_mov_b32 v33, v32
    v_mov_b32 v35, v34
    v_mov_b32 v37, v36
    v_mov_b32 v39, v38
    s_nop 1
    v_permlane16_swap_b32 v32, v33
    v_permlane16_swap_b32 v34, v35
    v_permlane16_swap_b32 v36, v37
    v_permlane16_swap_b32 v38, v39
    s_nop 1
    v_add_f32 v32, v32, v33
    v_add_f32 v34, v34, v35
    v_add_f32 v36, v36, v37
    v_add_f32 v38, v38, v39
    v_mov_b32 v33, v32
    v_mov_b32 v35, v34
    v_mov_b32 v37, v36
    v_mov_b32 v39, v38
    s_nop 1
    v_permlane32_swap_b32 v32, v33
    v_permlane32_swap_b32 v34, v35
    v_permlane32_swap_b32 v36, v37
    v_permlane32_swap_b32 v38, v39
    s_nop 1
    v_add_f32 v32, v32, v33
    v_add_f32 v34, v34, v35
    v_add_f32 v36, v36, v37
    v_add_f32 v38, v38, v39
    v_cvt_pk_bf16_f32 v32, v32, v32
    v_lshlrev_b32 v32, 16, v32
    v_cvt_pk_bf16_f32 v34, v34, v34
    v_lshlrev_b32 v34, 16, v34
    v_cvt_pk_bf16_f32 v36, v36, v36
    v_lshlrev_b32 v36, 16, v36
    v_cvt_pk_bf16_f32 v38, v38, v38
    v_lshlrev_b32 v38, 16, v38
    v_lshlrev_b32 v6, 16, v229
    v_and_b32 v7, 0xffff0000, v229
    v_add_f32 v36, v36, v6
    v_add_f32 v38, v38, v7
    v_cvt_pk_bf16_f32 v36, v36, v36
    v_lshlrev_b32 v36, 16, v36
    v_cvt_pk_bf16_f32 v38, v38, v38
    v_lshlrev_b32 v38, 16, v38
    s_mov_b32 s84, 0xbfb8aa3b
    v_mul_f32 v6, s84, v36
    v_mul_f32 v7, s84, v38
    v_exp_f32 v6, v6
    v_exp_f32 v7, v7
    s_nop 0
    v_add_f32 v6, 1.0, v6
    v_add_f32 v7, 1.0, v7
    v_rcp_f32 v6, v6
    v_rcp_f32 v7, v7
    s_nop 0
    v_mul_f32 v36, v36, v6
    v_mul_f32 v38, v38, v7
    v_cvt_pk_bf16_f32 v36, v36, v36
    v_lshlrev_b32 v36, 16, v36
    v_cvt_pk_bf16_f32 v38, v38, v38
    v_lshlrev_b32 v38, 16, v38
    v_mul_f32 v32, v32, v36
    v_mul_f32 v34, v34, v38
    v_cvt_pk_bf16_f32 v32, v32, v32
    v_lshlrev_b32 v32, 16, v32
    v_cvt_pk_bf16_f32 v34, v34, v34
    v_lshlrev_b32 v34, 16, v34
    v_lshlrev_b32 v6, 16, v228
    v_and_b32 v7, 0xffff0000, v228
    v_add_f32 v32, v32, v6
    v_add_f32 v34, v34, v7
    v_cvt_pk_bf16_f32 v32, v32, v34
    s_mov_b32 s64, s54
    s_and_b32 s65, s55, 0xffff
    s_mov_b32 s66, 0x1000
    s_mov_b32 s67, 0x00020000
    v_lshlrev_b32 v22, 2, v3
    s_lshl_b32 s80, s87, 4
    s_mov_b64 exec, 0xf
    buffer_store_dword v32, v22, s[64:67], s80 offen
    s_mov_b64 exec, -1
K2_fin:
K2_end:
    s_endpgm
.section .rodata,"a"
.p2align 6
.amdhsa_kernel recurrent_scan__gqa_block_cached__mixer_channel_mlp__decode_kernel
  .amdhsa_next_free_vgpr 230
  .amdhsa_next_free_sgpr 102
  .amdhsa_accum_offset 232
  .amdhsa_group_segment_fixed_size 0
  .amdhsa_kernarg_size 104
  .amdhsa_user_sgpr_count 2
  .amdhsa_user_sgpr_kernarg_segment_ptr 1
  .amdhsa_system_sgpr_workgroup_id_x 1
.end_amdhsa_kernel
```
